```python
import torch

def _softmax(x, axis=-1):
    return torch.softmax(x, dim=axis)
def _gelu(x):
    return torch.nn.functional.gelu(x, approximate="tanh")
def _silu(x):
    return torch.nn.functional.silu(x)
def _sigmoid(x):
    return torch.sigmoid(x)
def _layernorm(x, axis=-1, eps=1e-5):
    m = x.mean(dim=axis, keepdim=True)
    v = x.var(dim=axis, keepdim=True, unbiased=False)
    return (x - m) / torch.sqrt(v + eps)
def _scatter_add(tgt, idx, src, axis=0):
    return tgt.clone().index_add_(axis, idx, src)
def _segment_sum(src, seg, n):
    out = torch.zeros((n,) + src.shape[1:], dtype=src.dtype)
    return out.index_add_(0, seg, src)
def _pad(x, pw):
    flat = tuple(v for pair in reversed(pw) for v in pair)
    return torch.nn.functional.pad(x, flat)

kernel_name = 'gated_mix__ssm_conv_s4__linear_attn_block__prompt'

def setup_inputs():

    _w = (lambda a: (lambda t: t.to(torch.bfloat16) if t.is_floating_point() else t)(torch.as_tensor(a)))
    def _A_setup():
        B, L, D, N = 1, 2048, 512, 128
        A_re = -(lambda _x: torch.exp(torch.as_tensor(_x)))((lambda *s: torch.randn(*s, dtype=torch.bfloat16) * 6.4)(D, N))
        A_im = torch.pi * (lambda *s: torch.randn(*s, dtype=torch.bfloat16) * 0.05)(D, N)
        B_re = (lambda *s: torch.randn(*s, dtype=torch.bfloat16) * 0.2)(D, N)
        B_im = (lambda *s: torch.randn(*s, dtype=torch.bfloat16) * 0.2)(D, N)
        C_re = (lambda *s: torch.randn(*s, dtype=torch.bfloat16) * 0.2)(D, N)
        C_im = (lambda *s: torch.randn(*s, dtype=torch.bfloat16) * 0.2)(D, N)
        log_dt = (lambda *s: torch.randn(*s, dtype=torch.bfloat16) * 0.05)(D) * 0.5 - 4.0
        Dskip = (lambda *s: torch.randn(*s, dtype=torch.bfloat16) * 0.05)(D)
        return {
            "u": _w((lambda *s: torch.randn(*s, dtype=torch.bfloat16) * 0.05)(B, L, D)),
            "A_re": _w(A_re),
            "A_im": _w(A_im),
            "B_re": _w(B_re),
            "B_im": _w(B_im),
            "C_re": _w(C_re),
            "C_im": _w(C_im),
            "log_dt": _w(log_dt),
            "Dskip": _w(Dskip),
        }
    _A_in = _A_setup()

    def _B_setup():
        B, S, D = 1, 2048, 512
        return {
            "x": _w((lambda *s: torch.randn(*s, dtype=torch.bfloat16) * 0.05)(B, S, D)),
            "wqkv": _w((lambda *s: torch.randn(*s, dtype=torch.bfloat16) * 0.8)(D, 3 * D)),
            "wo": _w((lambda *s: torch.randn(*s, dtype=torch.bfloat16) * 0.05)(D, D)),
        }
    _B_in = _B_setup()

    return {
        "A_u": _A_in["u"],
        "A_A_re": _A_in["A_re"],
        "A_A_im": _A_in["A_im"],
        "A_B_re": _A_in["B_re"],
        "A_B_im": _A_in["B_im"],
        "A_C_re": _A_in["C_re"],
        "A_C_im": _A_in["C_im"],
        "A_log_dt": _A_in["log_dt"],
        "A_Dskip": _A_in["Dskip"],
        "B_x": _B_in["x"],
        "B_wqkv": _B_in["wqkv"],
        "B_wo": _B_in["wo"],
        "gate_w": _w((lambda *s: torch.randn(*s, dtype=torch.bfloat16) * 0.05)(512) * 16.0),
    }

def reference(A_u, A_A_re, A_A_im, A_B_re, A_B_im, A_C_re, A_C_im, A_log_dt, A_Dskip, B_x, B_wqkv, B_wo, gate_w):
    def _A_ref(u, A_re, A_im, B_re, B_im, C_re, C_im, log_dt, Dskip):
        Bsz, L, D = u.shape
        dt = torch.exp(log_dt)[:, None]
        A = A_re + 1j * A_im
        Bc = B_re + 1j * B_im
        Cc = C_re + 1j * C_im
        logdA = dt * A
        dB = dt * Bc
        l = (lambda x, dt: x.to(dt))(torch.arange(L), A_re.dtype)
        P = torch.exp(logdA[:, :, None] * l[None, None, :])
        K = torch.einsum("dn,dnl,dn->dl", Cc, P, dB).real
        L2 = 2 * L
        Kp = _pad(K, ((0, 0), (0, L)))
        up = (lambda x, *d: x.permute(*d))(u, 0, 2, 1)
        up = _pad(up, ((0, 0), (0, 0), (0, L)))
        Kf = (lambda x, axes=(-2,-1): torch.fft.rfft2(x.float(), dim=axes))(Kp[:, None, :], axes=(-2, -1))
        Uf = (lambda x, axes=(-2,-1): torch.fft.rfft2(x.float(), dim=axes))(up[:, :, None, :], axes=(-2, -1))
        Yf = Uf * Kf[None, :, :, :]
        y = (lambda x, s, axes=(-2,-1): torch.fft.irfft2(x, s=s, dim=axes).to(torch.bfloat16))(Yf, (1, L2), axes=(-2, -1))[:, :, 0, :L]
        y = (lambda x, *d: x.permute(*d))(y, 0, 2, 1) + u * Dskip[None, None, :]
        return y

    def _B_ref(x, wqkv, wo):
        B, S, D = x.shape
        H = 32; Dh = D // H
        qkv = (lambda x, *d: x.permute(*d))((x @ wqkv).reshape(B, S, 3, H, Dh), 2, 0, 3, 1, 4)
        q, k, v = qkv[0], qkv[1], qkv[2]
        phi = lambda t: torch.where(t > 0, t + 1, torch.exp(t)) + 1e-6
        pq, pk = phi(q), phi(k)
        kv = torch.einsum("bhsd,bhse->bhde", pk, v)
        z = torch.einsum("bhsd->bhd", pk)
        num = torch.einsum("bhqd,bhde->bhqe", pq, kv)
        den = torch.einsum("bhqd,bhd->bhq", pq, z)[..., None] + 1e-6
        o = num / den
        return (lambda x, *d: x.permute(*d))(o, 0, 2, 1, 3).reshape(B, S, D) @ wo

    x = A_u
    g = _sigmoid((x * gate_w).sum(-1, keepdims=True))
    a = _A_ref(x, A_A_re, A_A_im, A_B_re, A_B_im, A_C_re, A_C_im, A_log_dt, A_Dskip)
    b = _B_ref(x, B_wqkv, B_wo)
    return g * a + (1 - g) * b
```

```asm
; @launch grid=(256,1,1) block=(512,1,1) lds=163840
.amdgcn_target "amdgcn-amd-amdhsa--gfx950"
.text
.globl gated_mix__ssm_conv_s4__linear_attn_block__prompt_kernel
.p2align 8
.type gated_mix__ssm_conv_s4__linear_attn_block__prompt_kernel,@function
gated_mix__ssm_conv_s4__linear_attn_block__prompt_kernel:
    s_cmp_ge_u32 s2, 256
    s_cbranch_scc1 L_k1_end
    s_load_dwordx16 s[16:31], s[0:1], 0
    s_load_dwordx16 s[32:47], s[0:1], 64
    v_lshrrev_b32 v1, 6, v0
    s_nop 0
    v_readfirstlane_b32 s48, v1
    v_and_b32 v1, 63, v0
    s_cmp_eq_u32 s48, 7
    s_cbranch_scc0 L_nocpf
    s_getpc_b64 s[10:11]
    s_and_b32 s10, s10, 0xffffff00
    v_lshlrev_b32 v2, 7, v1
    global_load_dword v250, v2, s[10:11]
    v_add_u32 v2, 8192, v2
    global_load_dword v251, v2, s[10:11]
    v_add_u32 v2, 8192, v2
    s_mov_b64 exec, 0x3fffff
    global_load_dword v252, v2, s[10:11]
    s_mov_b64 exec, -1
L_nocpf:
    s_and_b32 s49, s2, 7
    s_lshr_b32 s50, s2, 3
    s_and_b32 s50, s50, 15
    s_bitcmp0_b32 s2, 7
    s_cbranch_scc1 L_roleB
    s_and_b32 s3, s2, 127
L_roleA:
    s_and_b32 s51, s48, 3
    s_lshr_b32 s52, s48, 2
    s_lshl_b32 s54, s49, 6
    s_lshl_b32 s56, s50, 2
    s_add_u32 s54, s54, s56
    s_add_u32 s53, s54, s51
    s_mul_i32 s55, s51, 31680
    s_mul_i32 s90, s51, 9280
    s_add_u32 s90, s90, 126720
    s_lshl_b32 s56, s53, 8
    v_lshlrev_b32 v26, 2, v1
    v_add_u32 v26, s56, v26
    s_waitcnt lgkmcnt(0)
    s_cmp_ge_u32 s3, 8
    s_cbranch_scc1 L_a_nozero
    s_add_u32 s60, s46, 4194304
    s_addc_u32 s61, s47, 0
    s_mov_b32 s62, 63488
    s_mov_b32 s63, 0x20000
    v_lshlrev_b32 v27, 4, v0
    s_lshl_b32 s66, s3, 13
    v_add_u32 v27, s66, v27
    v_mov_b32 v28, 0
    v_mov_b32 v29, 0
    v_mov_b32 v30, 0
    v_mov_b32 v31, 0
    buffer_store_dwordx4 v[28:31], v27, s[60:63], 0 offen sc1
L_a_nozero:
    global_load_dword v20, v26, s[18:19] nt
    global_load_dword v21, v26, s[20:21] nt
    s_lshl_b32 s56, s53, 1
    s_and_b32 s56, s56, 0xfffffffc
    s_load_dword s58, s[30:31], s56
    s_load_dword s59, s[32:33], s56
    s_cmp_eq_u32 s52, 0
    s_cbranch_scc0 L_a_gather
    global_load_dword v22, v26, s[22:23] nt
    global_load_dword v23, v26, s[24:25] nt
    global_load_dword v24, v26, s[26:27] nt
    global_load_dword v25, v26, s[28:29] nt
    s_lshl_b32 s92, s49, 4
    s_add_u32 s92, s92, s50
    s_mov_b32 s4, s38
    s_mov_b32 s5, s39
    s_mov_b32 s6, 524288
    s_mov_b32 s7, 0x20000
    s_and_b32 s56, s92, 7
    s_lshl_b32 s56, s56, 2
    s_add_u32 s93, s56, s51
    v_lshrrev_b32 v27, 1, v1
    v_lshlrev_b32 v27, 10, v27
    v_and_b32 v28, 1, v1
    v_lshl_add_u32 v27, v28, 4, v27
    s_lshr_b32 s56, s92, 3
    s_lshl_b32 s56, s56, 15
    s_lshl_b32 s57, s93, 5
    s_add_u32 s56, s56, s57
    s_lshl_b32 s57, s51, 10
    s_add_u32 m0, s57, 126720
    s_nop 0
    buffer_load_dwordx4 v27, s[4:7], s56 offen nt lds
    s_branch L_a_p1
L_a_gather:
    s_mov_b32 s64, s16
    s_mov_b32 s65, s17
    s_mov_b32 s66, 2097152
    s_mov_b32 s67, 0x20000
    v_and_b32 v27, 255, v0
    v_lshrrev_b32 v28, 3, v27
    s_lshl_b32 s56, s50, 7
    v_add_u32 v28, s56, v28
    v_lshlrev_b32 v28, 10, v28
    v_and_b32 v29, 7, v27
    v_lshl_add_u32 v28, v29, 4, v28
    s_lshl_b32 s56, s49, 7
    v_add_u32 v28, s56, v28
    s_mov_b32 s57, 0
    buffer_load_dwordx4 v[224:227], v28, s[64:67], s57 offen
    s_mov_b32 s57, 32768
    buffer_load_dwordx4 v[224:227], v28, s[64:67], s57 offen
    s_mov_b32 s57, 65536
    buffer_load_dwordx4 v[224:227], v28, s[64:67], s57 offen
    s_mov_b32 s57, 98304
    buffer_load_dwordx4 v[224:227], v28, s[64:67], s57 offen
    v_lshlrev_b32 v72, 13, v27
    s_lshl_b32 s56, s54, 1
    v_add_u32 v72, s56, v72
    v_add_u32 v73, 4096, v72
    v_subrev_u32 v74, 1024, v72
    v_cmp_eq_u32_e64 s[98:99], 0, v27
    v_mov_b32 v31, 0x7ffffff0
    s_nop 0
    v_cndmask_b32_e64 v74, v74, v31, s[98:99]
L_a_p1:
    v_and_b32 v140, 15, v1
    v_lshrrev_b32 v141, 4, v1
    v_and_b32 v142, 1, v140
    v_lshrrev_b32 v143, 1, v140
    v_mul_u32_u24 v128, 4640, v142
    v_lshl_add_u32 v128, v143, 6, v128
    v_lshl_add_u32 v128, v141, 4, v128
    s_mul_i32 s56, s52, 256
    s_sub_u32 s57, s90, s56
    s_add_u32 s57, s57, 512
    v_add_u32 v128, s57, v128
    v_sub_u32 v129, 1023, v140
    v_lshl_add_u32 v129, v141, 2, v129
    v_lshlrev_b32 v129, 2, v129
    v_sub_u32 v144, 1, v142
    v_mul_u32_u24 v144, 4220, v144
    v_add_u32 v129, v129, v144
    s_sub_u32 s57, s55, s56
    s_sub_u32 s57, s57, 3584
    v_add_u32 v129, s57, v129
    v_and_b32 v136, 15, v1
    v_lshlrev_b32 v136, 8, v136
    v_add_u32 v136, 4253696, v136
    v_lshlrev_b32 v130, 4, v1
    v_add_u32 v130, s55, v130
    v_lshlrev_b32 v131, 6, v143
    v_lshl_add_u32 v131, v141, 4, v131
    s_lshl_b32 s56, s52, 11
    s_add_u32 s57, s90, s56
    s_add_u32 s57, s57, 5152
    v_add_u32 v132, s57, v131
    v_lshl_add_u32 v131, v142, 9, v131
    s_lshl_b32 s57, s53, 12
    s_add_u32 s57, s57, s56
    v_add_u32 v131, s57, v131
    v_cmp_eq_u32_e64 s[8:9], 1, v142
    v_mov_b32 v133, 0x01000c0c
    v_mov_b32 v144, 0x03020c0c
    v_cndmask_b32_e64 v133, v133, v144, s[8:9]
    v_mov_b32 v134, 0x05040100
    v_mov_b32 v144, 0x01000504
    v_cndmask_b32_e64 v134, v134, v144, s[8:9]
    v_mov_b32 v135, 0x07060302
    v_mov_b32 v144, 0x03020706
    v_cndmask_b32_e64 v135, v135, v144, s[8:9]
    s_lshl_b32 s91, s49, 4
    s_add_u32 s91, s91, s50
    s_waitcnt lgkmcnt(0)
    s_bitcmp1_b32 s53, 0
    s_cselect_b32 s56, 16, 0
    s_lshr_b32 s58, s58, s56
    s_lshl_b32 s58, s58, 16
    s_lshr_b32 s59, s59, s56
    s_lshl_b32 s59, s59, 16
    v_mov_b32 v68, 1069066811
    v_mul_f32 v68, s58, v68
    v_exp_f32 v68, v68
    s_nop 0
    v_cvt_pk_bf16_f32 v68, v68, v68
    v_lshlrev_b32 v68, 16, v68
    v_lshlrev_b32 v69, 3, v1
    v_add_u32 v69, s55, v69
    s_cmp_eq_u32 s52, 0
    s_cbranch_scc0 L_a_p1B
    s_waitcnt vmcnt(0)
    s_cmp_ge_u32 s3, 8
    s_cbranch_scc1 L_a_ezA
    s_barrier
    s_cmp_lg_u32 s48, 0
    s_cbranch_scc1 L_a_ezA
    s_lshl_b32 s66, s3, 2
    v_mov_b32 v26, s66
    v_mov_b32 v27, 1
    s_mov_b64 exec, 1
    global_store_dword v26, v27, s[44:45] sc1
    s_mov_b64 exec, -1
L_a_ezA:
    v_lshlrev_b32 v26, 16, v20
    v_and_b32 v27, 0xffff0000, v20
    v_lshlrev_b32 v28, 16, v21
    v_and_b32 v29, 0xffff0000, v21
    s_mov_b32 s56, 1069066811
    s_mov_b32 s57, 1042479491
    v_mul_f32 v26, v26, v68
    v_mul_f32 v28, v28, v68
    v_mul_f32 v27, v27, v68
    v_mul_f32 v29, v29, v68
    v_mul_f32 v26, s56, v26
    v_mul_f32 v28, s57, v28
    v_mul_f32 v27, s56, v27
    v_mul_f32 v29, s57, v29
    v_exp_f32 v62, v26
    v_fract_f32 v63, v28
    v_cos_f32 v30, v63
    v_sin_f32 v31, v63
    v_mul_f32 v30, v30, v62
    v_mul_f32 v31, v31, v62
    v_exp_f32 v64, v27
    v_fract_f32 v65, v29
    v_cos_f32 v32, v65
    v_sin_f32 v33, v65
    v_mul_f32 v32, v32, v64
    v_mul_f32 v33, v33, v64
    s_mov_b32 s56, 0x43800000
    v_mul_f32 v62, s56, v26
    v_mul_f32 v63, s56, v28
    v_exp_f32 v62, v62
    v_fract_f32 v63, v63
    v_cos_f32 v34, v63
    v_sin_f32 v35, v63
    v_mul_f32 v34, v34, v62
    v_mul_f32 v35, v35, v62
    v_mul_f32 v64, s56, v27
    v_mul_f32 v65, s56, v29
    v_exp_f32 v64, v64
    v_fract_f32 v65, v65
    v_cos_f32 v36, v65
    v_sin_f32 v37, v65
    v_mul_f32 v36, v36, v64
    v_mul_f32 v37, v37, v64
    v_lshlrev_b32 v58, 16, v22
    v_and_b32 v60, 0xffff0000, v22
    v_lshlrev_b32 v59, 16, v23
    v_and_b32 v61, 0xffff0000, v23
    v_lshlrev_b32 v42, 16, v24
    v_and_b32 v44, 0xffff0000, v24
    v_lshlrev_b32 v43, 16, v25
    v_and_b32 v45, 0xffff0000, v25
    v_mul_f32 v58, v58, v68
    v_mul_f32 v59, v59, v68
    v_mul_f32 v60, v60, v68
    v_mul_f32 v61, v61, v68
    v_pk_mul_f32 v[62:63], v[42:43], v[58:59] op_sel:[0,0] op_sel_hi:[0,1]
    v_pk_mul_f32 v[64:65], v[44:45], v[60:61] op_sel:[0,0] op_sel_hi:[0,1]
    v_pk_fma_f32 v[38:39], v[42:43], v[58:59], v[62:63] op_sel:[1,1,0] op_sel_hi:[1,0,1] neg_lo:[1,0,0]
    v_pk_fma_f32 v[40:41], v[44:45], v[60:61], v[64:65] op_sel:[1,1,0] op_sel_hi:[1,0,1] neg_lo:[1,0,0]
    v_cvt_pk_bf16_f32 v66, v38, -v39
    v_cvt_pk_bf16_f32 v67, v40, -v41
    ds_write_b64 v69, v[66:67] offset:0
    v_pk_mul_f32 v[62:63], v[38:39], v[30:31] op_sel:[0,0] op_sel_hi:[0,1]
    v_pk_mul_f32 v[64:65], v[40:41], v[32:33] op_sel:[0,0] op_sel_hi:[0,1]
    v_pk_fma_f32 v[58:59], v[38:39], v[30:31], v[62:63] op_sel:[1,1,0] op_sel_hi:[1,0,1] neg_lo:[1,0,0]
    v_pk_fma_f32 v[60:61], v[40:41], v[32:33], v[64:65] op_sel:[1,1,0] op_sel_hi:[1,0,1] neg_lo:[1,0,0]
    v_cvt_pk_bf16_f32 v70, v58, -v59
    v_cvt_pk_bf16_f32 v71, v60, -v61
    ds_write_b64 v69, v[70:71] offset:528
    v_pk_mul_f32 v[62:63], v[58:59], v[30:31] op_sel:[0,0] op_sel_hi:[0,1]
    v_pk_mul_f32 v[64:65], v[60:61], v[32:33] op_sel:[0,0] op_sel_hi:[0,1]
    v_pk_fma_f32 v[42:43], v[58:59], v[30:31], v[62:63] op_sel:[1,1,0] op_sel_hi:[1,0,1] neg_lo:[1,0,0]
    v_pk_fma_f32 v[44:45], v[60:61], v[32:33], v[64:65] op_sel:[1,1,0] op_sel_hi:[1,0,1] neg_lo:[1,0,0]
    v_cvt_pk_bf16_f32 v66, v42, -v43
    v_cvt_pk_bf16_f32 v67, v44, -v45
    ds_write_b64 v69, v[66:67] offset:1056
    v_pk_mul_f32 v[62:63], v[42:43], v[30:31] op_sel:[0,0] op_sel_hi:[0,1]
    v_pk_mul_f32 v[64:65], v[44:45], v[32:33] op_sel:[0,0] op_sel_hi:[0,1]
    v_pk_fma_f32 v[58:59], v[42:43], v[30:31], v[62:63] op_sel:[1,1,0] op_sel_hi:[1,0,1] neg_lo:[1,0,0]
    v_pk_fma_f32 v[60:61], v[44:45], v[32:33], v[64:65] op_sel:[1,1,0] op_sel_hi:[1,0,1] neg_lo:[1,0,0]
    v_cvt_pk_bf16_f32 v70, v58, -v59
    v_cvt_pk_bf16_f32 v71, v60, -v61
    ds_write_b64 v69, v[70:71] offset:1584
    v_pk_mul_f32 v[62:63], v[58:59], v[30:31] op_sel:[0,0] op_sel_hi:[0,1]
    v_pk_mul_f32 v[64:65], v[60:61], v[32:33] op_sel:[0,0] op_sel_hi:[0,1]
    v_pk_fma_f32 v[46:47], v[58:59], v[30:31], v[62:63] op_sel:[1,1,0] op_sel_hi:[1,0,1] neg_lo:[1,0,0]
    v_pk_fma_f32 v[48:49], v[60:61], v[32:33], v[64:65] op_sel:[1,1,0] op_sel_hi:[1,0,1] neg_lo:[1,0,0]
    v_cvt_pk_bf16_f32 v66, v46, -v47
    v_cvt_pk_bf16_f32 v67, v48, -v49
    ds_write_b64 v69, v[66:67] offset:2112
    v_pk_mul_f32 v[62:63], v[46:47], v[30:31] op_sel:[0,0] op_sel_hi:[0,1]
    v_pk_mul_f32 v[64:65], v[48:49], v[32:33] op_sel:[0,0] op_sel_hi:[0,1]
    v_pk_fma_f32 v[58:59], v[46:47], v[30:31], v[62:63] op_sel:[1,1,0] op_sel_hi:[1,0,1] neg_lo:[1,0,0]
    v_pk_fma_f32 v[60:61], v[48:49], v[32:33], v[64:65] op_sel:[1,1,0] op_sel_hi:[1,0,1] neg_lo:[1,0,0]
    v_cvt_pk_bf16_f32 v70, v58, -v59
    v_cvt_pk_bf16_f32 v71, v60, -v61
    ds_write_b64 v69, v[70:71] offset:2640
    v_pk_mul_f32 v[62:63], v[58:59], v[30:31] op_sel:[0,0] op_sel_hi:[0,1]
    v_pk_mul_f32 v[64:65], v[60:61], v[32:33] op_sel:[0,0] op_sel_hi:[0,1]
    v_pk_fma_f32 v[50:51], v[58:59], v[30:31], v[62:63] op_sel:[1,1,0] op_sel_hi:[1,0,1] neg_lo:[1,0,0]
    v_pk_fma_f32 v[52:53], v[60:61], v[32:33], v[64:65] op_sel:[1,1,0] op_sel_hi:[1,0,1] neg_lo:[1,0,0]
    v_cvt_pk_bf16_f32 v66, v50, -v51
    v_cvt_pk_bf16_f32 v67, v52, -v53
    ds_write_b64 v69, v[66:67] offset:3168
    v_pk_mul_f32 v[62:63], v[50:51], v[30:31] op_sel:[0,0] op_sel_hi:[0,1]
    v_pk_mul_f32 v[64:65], v[52:53], v[32:33] op_sel:[0,0] op_sel_hi:[0,1]
    v_pk_fma_f32 v[58:59], v[50:51], v[30:31], v[62:63] op_sel:[1,1,0] op_sel_hi:[1,0,1] neg_lo:[1,0,0]
    v_pk_fma_f32 v[60:61], v[52:53], v[32:33], v[64:65] op_sel:[1,1,0] op_sel_hi:[1,0,1] neg_lo:[1,0,0]
    v_cvt_pk_bf16_f32 v70, v58, -v59
    v_cvt_pk_bf16_f32 v71, v60, -v61
    ds_write_b64 v69, v[70:71] offset:3696
    v_pk_mul_f32 v[62:63], v[58:59], v[30:31] op_sel:[0,0] op_sel_hi:[0,1]
    v_pk_mul_f32 v[64:65], v[60:61], v[32:33] op_sel:[0,0] op_sel_hi:[0,1]
    v_pk_fma_f32 v[54:55], v[58:59], v[30:31], v[62:63] op_sel:[1,1,0] op_sel_hi:[1,0,1] neg_lo:[1,0,0]
    v_pk_fma_f32 v[56:57], v[60:61], v[32:33], v[64:65] op_sel:[1,1,0] op_sel_hi:[1,0,1] neg_lo:[1,0,0]
    v_pk_mul_f32 v[62:63], v[38:39], v[34:35] op_sel:[0,0] op_sel_hi:[0,1]
    v_pk_mul_f32 v[64:65], v[40:41], v[36:37] op_sel:[0,0] op_sel_hi:[0,1]
    v_pk_fma_f32 v[38:39], v[38:39], v[34:35], v[62:63] op_sel:[1,1,0] op_sel_hi:[1,0,1] neg_lo:[1,0,0]
    v_pk_fma_f32 v[40:41], v[40:41], v[36:37], v[64:65] op_sel:[1,1,0] op_sel_hi:[1,0,1] neg_lo:[1,0,0]
    v_cvt_pk_bf16_f32 v66, v38, -v39
    v_cvt_pk_bf16_f32 v67, v40, -v41
    ds_write_b64 v69, v[66:67] offset:4224
    v_pk_mul_f32 v[62:63], v[42:43], v[34:35] op_sel:[0,0] op_sel_hi:[0,1]
    v_pk_mul_f32 v[64:65], v[44:45], v[36:37] op_sel:[0,0] op_sel_hi:[0,1]
    v_pk_fma_f32 v[42:43], v[42:43], v[34:35], v[62:63] op_sel:[1,1,0] op_sel_hi:[1,0,1] neg_lo:[1,0,0]
    v_pk_fma_f32 v[44:45], v[44:45], v[36:37], v[64:65] op_sel:[1,1,0] op_sel_hi:[1,0,1] neg_lo:[1,0,0]
    v_cvt_pk_bf16_f32 v70, v42, -v43
    v_cvt_pk_bf16_f32 v71, v44, -v45
    ds_write_b64 v69, v[70:71] offset:4752
    v_pk_mul_f32 v[62:63], v[46:47], v[34:35] op_sel:[0,0] op_sel_hi:[0,1]
    v_pk_mul_f32 v[64:65], v[48:49], v[36:37] op_sel:[0,0] op_sel_hi:[0,1]
    v_pk_fma_f32 v[46:47], v[46:47], v[34:35], v[62:63] op_sel:[1,1,0] op_sel_hi:[1,0,1] neg_lo:[1,0,0]
    v_pk_fma_f32 v[48:49], v[48:49], v[36:37], v[64:65] op_sel:[1,1,0] op_sel_hi:[1,0,1] neg_lo:[1,0,0]
    v_cvt_pk_bf16_f32 v66, v46, -v47
    v_cvt_pk_bf16_f32 v67, v48, -v49
    ds_write_b64 v69, v[66:67] offset:5280
    ds_write_b64 v69, v[66:67] offset:5808
    v_pk_mul_f32 v[62:63], v[50:51], v[34:35] op_sel:[0,0] op_sel_hi:[0,1]
    v_pk_mul_f32 v[64:65], v[52:53], v[36:37] op_sel:[0,0] op_sel_hi:[0,1]
    v_pk_fma_f32 v[50:51], v[50:51], v[34:35], v[62:63] op_sel:[1,1,0] op_sel_hi:[1,0,1] neg_lo:[1,0,0]
    v_pk_fma_f32 v[52:53], v[52:53], v[36:37], v[64:65] op_sel:[1,1,0] op_sel_hi:[1,0,1] neg_lo:[1,0,0]
    v_cvt_pk_bf16_f32 v70, v50, -v51
    v_cvt_pk_bf16_f32 v71, v52, -v53
    ds_write_b64 v69, v[70:71] offset:6336
    v_pk_mul_f32 v[62:63], v[54:55], v[34:35] op_sel:[0,0] op_sel_hi:[0,1]
    v_pk_mul_f32 v[64:65], v[56:57], v[36:37] op_sel:[0,0] op_sel_hi:[0,1]
    v_pk_fma_f32 v[54:55], v[54:55], v[34:35], v[62:63] op_sel:[1,1,0] op_sel_hi:[1,0,1] neg_lo:[1,0,0]
    v_pk_fma_f32 v[56:57], v[56:57], v[36:37], v[64:65] op_sel:[1,1,0] op_sel_hi:[1,0,1] neg_lo:[1,0,0]
    v_cvt_pk_bf16_f32 v66, v54, -v55
    v_cvt_pk_bf16_f32 v67, v56, -v57
    ds_write_b64 v69, v[66:67] offset:6864
    v_pk_mul_f32 v[62:63], v[38:39], v[34:35] op_sel:[0,0] op_sel_hi:[0,1]
    v_pk_mul_f32 v[64:65], v[40:41], v[36:37] op_sel:[0,0] op_sel_hi:[0,1]
    v_pk_fma_f32 v[38:39], v[38:39], v[34:35], v[62:63] op_sel:[1,1,0] op_sel_hi:[1,0,1] neg_lo:[1,0,0]
    v_pk_fma_f32 v[40:41], v[40:41], v[36:37], v[64:65] op_sel:[1,1,0] op_sel_hi:[1,0,1] neg_lo:[1,0,0]
    v_cvt_pk_bf16_f32 v70, v38, -v39
    v_cvt_pk_bf16_f32 v71, v40, -v41
    ds_write_b64 v69, v[70:71] offset:7392
    v_pk_mul_f32 v[62:63], v[46:47], v[34:35] op_sel:[0,0] op_sel_hi:[0,1]
    v_pk_mul_f32 v[64:65], v[48:49], v[36:37] op_sel:[0,0] op_sel_hi:[0,1]
    v_pk_fma_f32 v[46:47], v[46:47], v[34:35], v[62:63] op_sel:[1,1,0] op_sel_hi:[1,0,1] neg_lo:[1,0,0]
    v_pk_fma_f32 v[48:49], v[48:49], v[36:37], v[64:65] op_sel:[1,1,0] op_sel_hi:[1,0,1] neg_lo:[1,0,0]
    v_cvt_pk_bf16_f32 v66, v46, -v47
    v_cvt_pk_bf16_f32 v67, v48, -v49
    ds_write_b64 v69, v[66:67] offset:7920
    v_pk_mul_f32 v[62:63], v[54:55], v[34:35] op_sel:[0,0] op_sel_hi:[0,1]
    v_pk_mul_f32 v[64:65], v[56:57], v[36:37] op_sel:[0,0] op_sel_hi:[0,1]
    v_pk_fma_f32 v[54:55], v[54:55], v[34:35], v[62:63] op_sel:[1,1,0] op_sel_hi:[1,0,1] neg_lo:[1,0,0]
    v_pk_fma_f32 v[56:57], v[56:57], v[36:37], v[64:65] op_sel:[1,1,0] op_sel_hi:[1,0,1] neg_lo:[1,0,0]
    v_cvt_pk_bf16_f32 v70, v54, -v55
    v_cvt_pk_bf16_f32 v71, v56, -v57
    ds_write_b64 v69, v[70:71] offset:8448
    v_pk_mul_f32 v[62:63], v[38:39], v[34:35] op_sel:[0,0] op_sel_hi:[0,1]
    v_pk_mul_f32 v[64:65], v[40:41], v[36:37] op_sel:[0,0] op_sel_hi:[0,1]
    v_pk_fma_f32 v[38:39], v[38:39], v[34:35], v[62:63] op_sel:[1,1,0] op_sel_hi:[1,0,1] neg_lo:[1,0,0]
    v_pk_fma_f32 v[40:41], v[40:41], v[36:37], v[64:65] op_sel:[1,1,0] op_sel_hi:[1,0,1] neg_lo:[1,0,0]
    v_cvt_pk_bf16_f32 v66, v38, -v39
    v_cvt_pk_bf16_f32 v67, v40, -v41
    ds_write_b64 v69, v[66:67] offset:8976
    v_pk_mul_f32 v[62:63], v[46:47], v[34:35] op_sel:[0,0] op_sel_hi:[0,1]
    v_pk_mul_f32 v[64:65], v[48:49], v[36:37] op_sel:[0,0] op_sel_hi:[0,1]
    v_pk_fma_f32 v[46:47], v[46:47], v[34:35], v[62:63] op_sel:[1,1,0] op_sel_hi:[1,0,1] neg_lo:[1,0,0]
    v_pk_fma_f32 v[48:49], v[48:49], v[36:37], v[64:65] op_sel:[1,1,0] op_sel_hi:[1,0,1] neg_lo:[1,0,0]
    v_cvt_pk_bf16_f32 v70, v46, -v47
    v_cvt_pk_bf16_f32 v71, v48, -v49
    ds_write_b64 v69, v[70:71] offset:9504
    v_pk_mul_f32 v[62:63], v[54:55], v[34:35] op_sel:[0,0] op_sel_hi:[0,1]
    v_pk_mul_f32 v[64:65], v[56:57], v[36:37] op_sel:[0,0] op_sel_hi:[0,1]
    v_pk_fma_f32 v[54:55], v[54:55], v[34:35], v[62:63] op_sel:[1,1,0] op_sel_hi:[1,0,1] neg_lo:[1,0,0]
    v_pk_fma_f32 v[56:57], v[56:57], v[36:37], v[64:65] op_sel:[1,1,0] op_sel_hi:[1,0,1] neg_lo:[1,0,0]
    v_cvt_pk_bf16_f32 v66, v54, -v55
    v_cvt_pk_bf16_f32 v67, v56, -v57
    ds_write_b64 v69, v[66:67] offset:10032
    v_pk_mul_f32 v[62:63], v[38:39], v[34:35] op_sel:[0,0] op_sel_hi:[0,1]
    v_pk_mul_f32 v[64:65], v[40:41], v[36:37] op_sel:[0,0] op_sel_hi:[0,1]
    v_pk_fma_f32 v[38:39], v[38:39], v[34:35], v[62:63] op_sel:[1,1,0] op_sel_hi:[1,0,1] neg_lo:[1,0,0]
    v_pk_fma_f32 v[40:41], v[40:41], v[36:37], v[64:65] op_sel:[1,1,0] op_sel_hi:[1,0,1] neg_lo:[1,0,0]
    v_cvt_pk_bf16_f32 v70, v38, -v39
    v_cvt_pk_bf16_f32 v71, v40, -v41
    ds_write_b64 v69, v[70:71] offset:10560
    v_pk_mul_f32 v[62:63], v[54:55], v[34:35] op_sel:[0,0] op_sel_hi:[0,1]
    v_pk_mul_f32 v[64:65], v[56:57], v[36:37] op_sel:[0,0] op_sel_hi:[0,1]
    v_pk_fma_f32 v[54:55], v[54:55], v[34:35], v[62:63] op_sel:[1,1,0] op_sel_hi:[1,0,1] neg_lo:[1,0,0]
    v_pk_fma_f32 v[56:57], v[56:57], v[36:37], v[64:65] op_sel:[1,1,0] op_sel_hi:[1,0,1] neg_lo:[1,0,0]
    v_cvt_pk_bf16_f32 v66, v54, -v55
    v_cvt_pk_bf16_f32 v67, v56, -v57
    ds_write_b64 v69, v[66:67] offset:11088
    v_pk_mul_f32 v[62:63], v[38:39], v[34:35] op_sel:[0,0] op_sel_hi:[0,1]
    v_pk_mul_f32 v[64:65], v[40:41], v[36:37] op_sel:[0,0] op_sel_hi:[0,1]
    v_pk_fma_f32 v[38:39], v[38:39], v[34:35], v[62:63] op_sel:[1,1,0] op_sel_hi:[1,0,1] neg_lo:[1,0,0]
    v_pk_fma_f32 v[40:41], v[40:41], v[36:37], v[64:65] op_sel:[1,1,0] op_sel_hi:[1,0,1] neg_lo:[1,0,0]
    v_cvt_pk_bf16_f32 v70, v38, -v39
    v_cvt_pk_bf16_f32 v71, v40, -v41
    ds_write_b64 v69, v[70:71] offset:11616
    v_pk_mul_f32 v[62:63], v[54:55], v[34:35] op_sel:[0,0] op_sel_hi:[0,1]
    v_pk_mul_f32 v[64:65], v[56:57], v[36:37] op_sel:[0,0] op_sel_hi:[0,1]
    v_pk_fma_f32 v[54:55], v[54:55], v[34:35], v[62:63] op_sel:[1,1,0] op_sel_hi:[1,0,1] neg_lo:[1,0,0]
    v_pk_fma_f32 v[56:57], v[56:57], v[36:37], v[64:65] op_sel:[1,1,0] op_sel_hi:[1,0,1] neg_lo:[1,0,0]
    v_cvt_pk_bf16_f32 v66, v54, -v55
    v_cvt_pk_bf16_f32 v67, v56, -v57
    ds_write_b64 v69, v[66:67] offset:12144
    v_pk_mul_f32 v[62:63], v[38:39], v[34:35] op_sel:[0,0] op_sel_hi:[0,1]
    v_pk_mul_f32 v[64:65], v[40:41], v[36:37] op_sel:[0,0] op_sel_hi:[0,1]
    v_pk_fma_f32 v[38:39], v[38:39], v[34:35], v[62:63] op_sel:[1,1,0] op_sel_hi:[1,0,1] neg_lo:[1,0,0]
    v_pk_fma_f32 v[40:41], v[40:41], v[36:37], v[64:65] op_sel:[1,1,0] op_sel_hi:[1,0,1] neg_lo:[1,0,0]
    v_cvt_pk_bf16_f32 v70, v38, -v39
    v_cvt_pk_bf16_f32 v71, v40, -v41
    ds_write_b64 v69, v[70:71] offset:12672
    v_pk_mul_f32 v[62:63], v[54:55], v[34:35] op_sel:[0,0] op_sel_hi:[0,1]
    v_pk_mul_f32 v[64:65], v[56:57], v[36:37] op_sel:[0,0] op_sel_hi:[0,1]
    v_pk_fma_f32 v[54:55], v[54:55], v[34:35], v[62:63] op_sel:[1,1,0] op_sel_hi:[1,0,1] neg_lo:[1,0,0]
    v_pk_fma_f32 v[56:57], v[56:57], v[36:37], v[64:65] op_sel:[1,1,0] op_sel_hi:[1,0,1] neg_lo:[1,0,0]
    v_cvt_pk_bf16_f32 v66, v54, -v55
    v_cvt_pk_bf16_f32 v67, v56, -v57
    ds_write_b64 v69, v[66:67] offset:13200
    v_pk_mul_f32 v[62:63], v[38:39], v[34:35] op_sel:[0,0] op_sel_hi:[0,1]
    v_pk_mul_f32 v[64:65], v[40:41], v[36:37] op_sel:[0,0] op_sel_hi:[0,1]
    v_pk_fma_f32 v[38:39], v[38:39], v[34:35], v[62:63] op_sel:[1,1,0] op_sel_hi:[1,0,1] neg_lo:[1,0,0]
    v_pk_fma_f32 v[40:41], v[40:41], v[36:37], v[64:65] op_sel:[1,1,0] op_sel_hi:[1,0,1] neg_lo:[1,0,0]
    v_cvt_pk_bf16_f32 v70, v38, -v39
    v_cvt_pk_bf16_f32 v71, v40, -v41
    ds_write_b64 v69, v[70:71] offset:13728
    v_pk_mul_f32 v[62:63], v[54:55], v[34:35] op_sel:[0,0] op_sel_hi:[0,1]
    v_pk_mul_f32 v[64:65], v[56:57], v[36:37] op_sel:[0,0] op_sel_hi:[0,1]
    v_pk_fma_f32 v[54:55], v[54:55], v[34:35], v[62:63] op_sel:[1,1,0] op_sel_hi:[1,0,1] neg_lo:[1,0,0]
    v_pk_fma_f32 v[56:57], v[56:57], v[36:37], v[64:65] op_sel:[1,1,0] op_sel_hi:[1,0,1] neg_lo:[1,0,0]
    v_cvt_pk_bf16_f32 v66, v54, -v55
    v_cvt_pk_bf16_f32 v67, v56, -v57
    ds_write_b64 v69, v[66:67] offset:14256
    v_and_b32 v38, 15, v1
    v_lshrrev_b32 v39, 2, v38
    v_bfe_u32 v40, v1, 4, 1
    v_lshl_add_u32 v39, v40, 2, v39
    v_lshrrev_b32 v40, 5, v1
    v_lshl_add_u32 v39, v40, 4, v39
    v_lshlrev_b32 v39, 5, v39
    v_and_b32 v40, 3, v38
    v_lshl_add_u32 v39, v40, 3, v39
    s_lshl_b32 s57, s51, 10
    s_add_u32 s57, s57, 126720
    v_add_u32 v39, s57, v39
    ds_read_b64_tr_b16 v[42:43], v39
    ds_read_b64_tr_b16 v[44:45], v39 offset:256
    s_lshr_b32 s56, s92, 3
    s_lshl_b32 s56, s56, 5
    s_add_u32 s56, s56, s93
    s_lshl_b32 s56, s56, 10
    s_add_u32 s56, s56, 5242880
    v_lshlrev_b32 v40, 4, v1
    v_add_u32 v40, s56, v40
    s_waitcnt lgkmcnt(0)
    global_store_dwordx4 v40, v[42:45], s[46:47] sc1
    s_branch L_a_p1done
L_a_p1B:
    s_waitcnt vmcnt(4)
    s_cmp_ge_u32 s3, 8
    s_cbranch_scc1 L_a_ezB
    s_barrier
    s_cmp_lg_u32 s48, 0
    s_cbranch_scc1 L_a_ezB
    s_lshl_b32 s66, s3, 2
    v_mov_b32 v26, s66
    v_mov_b32 v27, 1
    s_mov_b64 exec, 1
    global_store_dword v26, v27, s[44:45] sc1
    s_mov_b64 exec, -1
L_a_ezB:
    s_mov_b64 exec, 1
    buffer_load_dwordx2 v[2:3], v74, s[64:67], 0 offen
    s_mov_b64 exec, -1
    buffer_load_dwordx2 v[4:5], v72, s[64:67], 0 offen offset:0
    buffer_load_dwordx2 v[6:7], v72, s[64:67], 0 offen offset:1024
    buffer_load_dwordx2 v[8:9], v72, s[64:67], 0 offen offset:2048
    buffer_load_dwordx2 v[10:11], v72, s[64:67], 0 offen offset:3072
    v_lshlrev_b32 v26, 16, v20
    v_and_b32 v27, 0xffff0000, v20
    v_lshlrev_b32 v28, 16, v21
    v_and_b32 v29, 0xffff0000, v21
    s_mov_b32 s56, 1069066811
    s_mov_b32 s57, 1042479491
    v_mul_f32 v26, v26, v68
    v_mul_f32 v28, v28, v68
    v_mul_f32 v27, v27, v68
    v_mul_f32 v29, v29, v68
    v_mul_f32 v26, s56, v26
    v_mul_f32 v28, s57, v28
    v_mul_f32 v27, s56, v27
    v_mul_f32 v29, s57, v29
    s_mov_b32 s56, 0x41000000
    v_mul_f32 v62, s56, v26
    v_mul_f32 v63, s56, v28
    v_exp_f32 v62, v62
    v_fract_f32 v63, v63
    v_cos_f32 v30, v63
    v_sin_f32 v31, v63
    v_mul_f32 v30, v30, v62
    v_mul_f32 v31, v31, v62
    v_mul_f32 v64, s56, v27
    v_mul_f32 v65, s56, v29
    v_exp_f32 v64, v64
    v_fract_f32 v65, v65
    v_cos_f32 v32, v65
    v_sin_f32 v33, v65
    v_mul_f32 v32, v32, v64
    v_mul_f32 v33, v33, v64
    v_mov_b32 v34, 1.0
    v_mov_b32 v35, 0
    v_mov_b32 v36, 1.0
    v_mov_b32 v37, 0
    v_add_u32 v69, 14784, v69
    s_mov_b32 s56, 3
L_a_p1Bloop1:
    v_cvt_pk_bf16_f32 v66, v34, v35
    v_cvt_pk_bf16_f32 v67, v36, v37
    v_pk_mul_f32 v[62:63], v[34:35], v[30:31] op_sel:[0,0] op_sel_hi:[0,1]
    v_pk_mul_f32 v[64:65], v[36:37], v[32:33] op_sel:[0,0] op_sel_hi:[0,1]
    v_pk_fma_f32 v[34:35], v[34:35], v[30:31], v[62:63] op_sel:[1,1,0] op_sel_hi:[1,0,1] neg_lo:[1,0,0]
    v_pk_fma_f32 v[36:37], v[36:37], v[32:33], v[64:65] op_sel:[1,1,0] op_sel_hi:[1,0,1] neg_lo:[1,0,0]
    ds_write_b64 v69, v[66:67] offset:0
    v_cvt_pk_bf16_f32 v70, v34, v35
    v_cvt_pk_bf16_f32 v71, v36, v37
    v_pk_mul_f32 v[62:63], v[34:35], v[30:31] op_sel:[0,0] op_sel_hi:[0,1]
    v_pk_mul_f32 v[64:65], v[36:37], v[32:33] op_sel:[0,0] op_sel_hi:[0,1]
    v_pk_fma_f32 v[34:35], v[34:35], v[30:31], v[62:63] op_sel:[1,1,0] op_sel_hi:[1,0,1] neg_lo:[1,0,0]
    v_pk_fma_f32 v[36:37], v[36:37], v[32:33], v[64:65] op_sel:[1,1,0] op_sel_hi:[1,0,1] neg_lo:[1,0,0]
    ds_write_b64 v69, v[70:71] offset:528
    v_cvt_pk_bf16_f32 v66, v34, v35
    v_cvt_pk_bf16_f32 v67, v36, v37
    v_pk_mul_f32 v[62:63], v[34:35], v[30:31] op_sel:[0,0] op_sel_hi:[0,1]
    v_pk_mul_f32 v[64:65], v[36:37], v[32:33] op_sel:[0,0] op_sel_hi:[0,1]
    v_pk_fma_f32 v[34:35], v[34:35], v[30:31], v[62:63] op_sel:[1,1,0] op_sel_hi:[1,0,1] neg_lo:[1,0,0]
    v_pk_fma_f32 v[36:37], v[36:37], v[32:33], v[64:65] op_sel:[1,1,0] op_sel_hi:[1,0,1] neg_lo:[1,0,0]
    ds_write_b64 v69, v[66:67] offset:1056
    v_cvt_pk_bf16_f32 v70, v34, v35
    v_cvt_pk_bf16_f32 v71, v36, v37
    v_pk_mul_f32 v[62:63], v[34:35], v[30:31] op_sel:[0,0] op_sel_hi:[0,1]
    v_pk_mul_f32 v[64:65], v[36:37], v[32:33] op_sel:[0,0] op_sel_hi:[0,1]
    v_pk_fma_f32 v[34:35], v[34:35], v[30:31], v[62:63] op_sel:[1,1,0] op_sel_hi:[1,0,1] neg_lo:[1,0,0]
    v_pk_fma_f32 v[36:37], v[36:37], v[32:33], v[64:65] op_sel:[1,1,0] op_sel_hi:[1,0,1] neg_lo:[1,0,0]
    ds_write_b64 v69, v[70:71] offset:1584
    v_add_u32 v69, 2112, v69
    s_sub_u32 s56, s56, 1
    s_cmp_lg_u32 s56, 0
    s_cbranch_scc1 L_a_p1Bloop1
    s_mov_b32 s56, 3
L_a_p1Bloop2:
    v_cvt_pk_bf16_f32 v66, v34, v35
    v_cvt_pk_bf16_f32 v67, v36, v37
    v_pk_mul_f32 v[62:63], v[34:35], v[30:31] op_sel:[0,0] op_sel_hi:[0,1]
    v_pk_mul_f32 v[64:65], v[36:37], v[32:33] op_sel:[0,0] op_sel_hi:[0,1]
    v_pk_fma_f32 v[34:35], v[34:35], v[30:31], v[62:63] op_sel:[1,1,0] op_sel_hi:[1,0,1] neg_lo:[1,0,0]
    v_pk_fma_f32 v[36:37], v[36:37], v[32:33], v[64:65] op_sel:[1,1,0] op_sel_hi:[1,0,1] neg_lo:[1,0,0]
    ds_write_b64 v69, v[66:67] offset:0
    v_cvt_pk_bf16_f32 v70, v34, v35
    v_cvt_pk_bf16_f32 v71, v36, v37
    v_pk_mul_f32 v[62:63], v[34:35], v[30:31] op_sel:[0,0] op_sel_hi:[0,1]
    v_pk_mul_f32 v[64:65], v[36:37], v[32:33] op_sel:[0,0] op_sel_hi:[0,1]
    v_pk_fma_f32 v[34:35], v[34:35], v[30:31], v[62:63] op_sel:[1,1,0] op_sel_hi:[1,0,1] neg_lo:[1,0,0]
    v_pk_fma_f32 v[36:37], v[36:37], v[32:33], v[64:65] op_sel:[1,1,0] op_sel_hi:[1,0,1] neg_lo:[1,0,0]
    ds_write_b64 v69, v[70:71] offset:528
    v_cvt_pk_bf16_f32 v66, v34, v35
    v_cvt_pk_bf16_f32 v67, v36, v37
    v_pk_mul_f32 v[62:63], v[34:35], v[30:31] op_sel:[0,0] op_sel_hi:[0,1]
    v_pk_mul_f32 v[64:65], v[36:37], v[32:33] op_sel:[0,0] op_sel_hi:[0,1]
    v_pk_fma_f32 v[34:35], v[34:35], v[30:31], v[62:63] op_sel:[1,1,0] op_sel_hi:[1,0,1] neg_lo:[1,0,0]
    v_pk_fma_f32 v[36:37], v[36:37], v[32:33], v[64:65] op_sel:[1,1,0] op_sel_hi:[1,0,1] neg_lo:[1,0,0]
    ds_write_b64 v69, v[66:67] offset:1056
    v_cvt_pk_bf16_f32 v70, v34, v35
    v_cvt_pk_bf16_f32 v71, v36, v37
    v_pk_mul_f32 v[62:63], v[34:35], v[30:31] op_sel:[0,0] op_sel_hi:[0,1]
    v_pk_mul_f32 v[64:65], v[36:37], v[32:33] op_sel:[0,0] op_sel_hi:[0,1]
    v_pk_fma_f32 v[34:35], v[34:35], v[30:31], v[62:63] op_sel:[1,1,0] op_sel_hi:[1,0,1] neg_lo:[1,0,0]
    v_pk_fma_f32 v[36:37], v[36:37], v[32:33], v[64:65] op_sel:[1,1,0] op_sel_hi:[1,0,1] neg_lo:[1,0,0]
    ds_write_b64 v69, v[70:71] offset:1584
    v_add_u32 v69, 2112, v69
    s_sub_u32 s56, s56, 1
    s_cmp_lg_u32 s56, 0
    s_cbranch_scc1 L_a_p1Bloop2
    v_cvt_pk_bf16_f32 v66, v34, v35
    v_cvt_pk_bf16_f32 v67, v36, v37
    v_pk_mul_f32 v[62:63], v[34:35], v[30:31] op_sel:[0,0] op_sel_hi:[0,1]
    v_pk_mul_f32 v[64:65], v[36:37], v[32:33] op_sel:[0,0] op_sel_hi:[0,1]
    v_pk_fma_f32 v[34:35], v[34:35], v[30:31], v[62:63] op_sel:[1,1,0] op_sel_hi:[1,0,1] neg_lo:[1,0,0]
    v_pk_fma_f32 v[36:37], v[36:37], v[32:33], v[64:65] op_sel:[1,1,0] op_sel_hi:[1,0,1] neg_lo:[1,0,0]
    ds_write_b64 v69, v[66:67] offset:0
    v_cvt_pk_bf16_f32 v70, v34, v35
    v_cvt_pk_bf16_f32 v71, v36, v37
    v_pk_mul_f32 v[62:63], v[34:35], v[30:31] op_sel:[0,0] op_sel_hi:[0,1]
    v_pk_mul_f32 v[64:65], v[36:37], v[32:33] op_sel:[0,0] op_sel_hi:[0,1]
    v_pk_fma_f32 v[34:35], v[34:35], v[30:31], v[62:63] op_sel:[1,1,0] op_sel_hi:[1,0,1] neg_lo:[1,0,0]
    v_pk_fma_f32 v[36:37], v[36:37], v[32:33], v[64:65] op_sel:[1,1,0] op_sel_hi:[1,0,1] neg_lo:[1,0,0]
    ds_write_b64 v69, v[70:71] offset:528
    v_cvt_pk_bf16_f32 v66, v34, v35
    v_cvt_pk_bf16_f32 v67, v36, v37
    v_pk_mul_f32 v[62:63], v[34:35], v[30:31] op_sel:[0,0] op_sel_hi:[0,1]
    v_pk_mul_f32 v[64:65], v[36:37], v[32:33] op_sel:[0,0] op_sel_hi:[0,1]
    v_pk_fma_f32 v[34:35], v[34:35], v[30:31], v[62:63] op_sel:[1,1,0] op_sel_hi:[1,0,1] neg_lo:[1,0,0]
    v_pk_fma_f32 v[36:37], v[36:37], v[32:33], v[64:65] op_sel:[1,1,0] op_sel_hi:[1,0,1] neg_lo:[1,0,0]
    ds_write_b64 v69, v[66:67] offset:1056
    v_cvt_pk_bf16_f32 v70, v34, v35
    v_cvt_pk_bf16_f32 v71, v36, v37
    v_pk_mul_f32 v[62:63], v[34:35], v[30:31] op_sel:[0,0] op_sel_hi:[0,1]
    v_pk_mul_f32 v[64:65], v[36:37], v[32:33] op_sel:[0,0] op_sel_hi:[0,1]
    v_pk_fma_f32 v[34:35], v[34:35], v[30:31], v[62:63] op_sel:[1,1,0] op_sel_hi:[1,0,1] neg_lo:[1,0,0]
    v_pk_fma_f32 v[36:37], v[36:37], v[32:33], v[64:65] op_sel:[1,1,0] op_sel_hi:[1,0,1] neg_lo:[1,0,0]
    ds_write_b64 v69, v[70:71] offset:1584
    v_add_u32 v69, 2112, v69
    v_cvt_pk_bf16_f32 v66, v34, v35
    v_cvt_pk_bf16_f32 v67, v36, v37
    v_pk_mul_f32 v[62:63], v[34:35], v[30:31] op_sel:[0,0] op_sel_hi:[0,1]
    v_pk_mul_f32 v[64:65], v[36:37], v[32:33] op_sel:[0,0] op_sel_hi:[0,1]
    v_pk_fma_f32 v[34:35], v[34:35], v[30:31], v[62:63] op_sel:[1,1,0] op_sel_hi:[1,0,1] neg_lo:[1,0,0]
    v_pk_fma_f32 v[36:37], v[36:37], v[32:33], v[64:65] op_sel:[1,1,0] op_sel_hi:[1,0,1] neg_lo:[1,0,0]
    ds_write_b64 v69, v[66:67] offset:0
    v_cvt_pk_bf16_f32 v70, v34, v35
    v_cvt_pk_bf16_f32 v71, v36, v37
    v_pk_mul_f32 v[62:63], v[34:35], v[30:31] op_sel:[0,0] op_sel_hi:[0,1]
    v_pk_mul_f32 v[64:65], v[36:37], v[32:33] op_sel:[0,0] op_sel_hi:[0,1]
    v_pk_fma_f32 v[34:35], v[34:35], v[30:31], v[62:63] op_sel:[1,1,0] op_sel_hi:[1,0,1] neg_lo:[1,0,0]
    v_pk_fma_f32 v[36:37], v[36:37], v[32:33], v[64:65] op_sel:[1,1,0] op_sel_hi:[1,0,1] neg_lo:[1,0,0]
    ds_write_b64 v69, v[70:71] offset:528
    v_cvt_pk_bf16_f32 v66, v34, v35
    v_cvt_pk_bf16_f32 v67, v36, v37
    v_pk_mul_f32 v[62:63], v[34:35], v[30:31] op_sel:[0,0] op_sel_hi:[0,1]
    v_pk_mul_f32 v[64:65], v[36:37], v[32:33] op_sel:[0,0] op_sel_hi:[0,1]
    v_pk_fma_f32 v[34:35], v[34:35], v[30:31], v[62:63] op_sel:[1,1,0] op_sel_hi:[1,0,1] neg_lo:[1,0,0]
    v_pk_fma_f32 v[36:37], v[36:37], v[32:33], v[64:65] op_sel:[1,1,0] op_sel_hi:[1,0,1] neg_lo:[1,0,0]
    ds_write_b64 v69, v[66:67] offset:1056
    v_cvt_pk_bf16_f32 v70, v34, v35
    v_cvt_pk_bf16_f32 v71, v36, v37
    v_pk_mul_f32 v[62:63], v[34:35], v[30:31] op_sel:[0,0] op_sel_hi:[0,1]
    v_pk_mul_f32 v[64:65], v[36:37], v[32:33] op_sel:[0,0] op_sel_hi:[0,1]
    v_pk_fma_f32 v[34:35], v[34:35], v[30:31], v[62:63] op_sel:[1,1,0] op_sel_hi:[1,0,1] neg_lo:[1,0,0]
    v_pk_fma_f32 v[36:37], v[36:37], v[32:33], v[64:65] op_sel:[1,1,0] op_sel_hi:[1,0,1] neg_lo:[1,0,0]
    ds_write_b64 v69, v[70:71] offset:1584
    v_add_u32 v69, 2112, v69
L_a_p1done:
    v_and_b32 v24, 7, v1
    v_lshlrev_b32 v24, 2, v24
    s_waitcnt lgkmcnt(0)
    s_barrier
    s_cmp_eq_u32 s52, 0
    s_cbranch_scc0 L_a_utab
    global_load_dword v25, v24, s[44:45] sc1
    v_and_b32 v28, 31, v1
    v_lshrrev_b32 v29, 5, v1
    v_subrev_u32 v30, 8, v28
    v_max_i32 v30, 0, v30
    v_lshrrev_b32 v30, 2, v30
    v_min_u32 v30, 4, v30
    v_sub_u32 v30, v28, v30
    v_mul_u32_u24 v26, 528, v30
    v_mul_u32_u24 v27, 528, v28
    v_lshlrev_b32 v31, 4, v29
    v_add_u32 v31, s55, v31
    v_add_u32 v26, v26, v31
    v_add_u32 v27, v27, v31
    ds_read_b128 v[36:39], v26 offset:0
    ds_read_b128 v[148:151], v27 offset:14784
    ds_read_b128 v[40:43], v26 offset:32
    ds_read_b128 v[152:155], v27 offset:14816
    ds_read_b128 v[44:47], v26 offset:64
    ds_read_b128 v[156:159], v27 offset:14848
    ds_read_b128 v[48:51], v26 offset:96
    ds_read_b128 v[160:163], v27 offset:14880
    ds_read_b128 v[52:55], v26 offset:128
    ds_read_b128 v[164:167], v27 offset:14912
    ds_read_b128 v[56:59], v26 offset:160
    ds_read_b128 v[168:171], v27 offset:14944
    s_waitcnt lgkmcnt(10)
    v_mfma_f32_32x32x16_bf16 v[100:115], v[36:39], v[148:151], 0
    ds_read_b128 v[60:63], v26 offset:192
    ds_read_b128 v[172:175], v27 offset:14976
    s_waitcnt lgkmcnt(10)
    v_mfma_f32_32x32x16_bf16 v[100:115], v[40:43], v[152:155], v[100:115]
    ds_read_b128 v[64:67], v26 offset:224
    ds_read_b128 v[176:179], v27 offset:15008
    s_waitcnt lgkmcnt(10)
    v_mfma_f32_32x32x16_bf16 v[100:115], v[44:47], v[156:159], v[100:115]
    ds_read_b128 v[36:39], v26 offset:256
    ds_read_b128 v[148:151], v27 offset:15040
    s_waitcnt lgkmcnt(10)
    v_mfma_f32_32x32x16_bf16 v[100:115], v[48:51], v[160:163], v[100:115]
    ds_read_b128 v[40:43], v26 offset:288
    ds_read_b128 v[152:155], v27 offset:15072
    s_waitcnt lgkmcnt(10)
    v_mfma_f32_32x32x16_bf16 v[100:115], v[52:55], v[164:167], v[100:115]
    ds_read_b128 v[44:47], v26 offset:320
    ds_read_b128 v[156:159], v27 offset:15104
    s_waitcnt lgkmcnt(10)
    v_mfma_f32_32x32x16_bf16 v[100:115], v[56:59], v[168:171], v[100:115]
    ds_read_b128 v[48:51], v26 offset:352
    ds_read_b128 v[160:163], v27 offset:15136
    s_waitcnt lgkmcnt(10)
    v_mfma_f32_32x32x16_bf16 v[100:115], v[60:63], v[172:175], v[100:115]
    ds_read_b128 v[52:55], v26 offset:384
    ds_read_b128 v[164:167], v27 offset:15168
    s_waitcnt lgkmcnt(10)
    v_mfma_f32_32x32x16_bf16 v[100:115], v[64:67], v[176:179], v[100:115]
    ds_read_b128 v[56:59], v26 offset:416
    ds_read_b128 v[168:171], v27 offset:15200
    s_waitcnt lgkmcnt(10)
    v_mfma_f32_32x32x16_bf16 v[100:115], v[36:39], v[148:151], v[100:115]
    ds_read_b128 v[60:63], v26 offset:448
    ds_read_b128 v[172:175], v27 offset:15232
    s_waitcnt lgkmcnt(10)
    v_mfma_f32_32x32x16_bf16 v[100:115], v[40:43], v[152:155], v[100:115]
    ds_read_b128 v[64:67], v26 offset:480
    ds_read_b128 v[176:179], v27 offset:15264
    s_waitcnt lgkmcnt(10)
    v_mfma_f32_32x32x16_bf16 v[100:115], v[44:47], v[156:159], v[100:115]
    s_waitcnt lgkmcnt(8)
    v_mfma_f32_32x32x16_bf16 v[100:115], v[48:51], v[160:163], v[100:115]
    s_waitcnt lgkmcnt(6)
    v_mfma_f32_32x32x16_bf16 v[100:115], v[52:55], v[164:167], v[100:115]
    s_waitcnt lgkmcnt(4)
    v_mfma_f32_32x32x16_bf16 v[100:115], v[56:59], v[168:171], v[100:115]
    s_waitcnt lgkmcnt(2)
    v_mfma_f32_32x32x16_bf16 v[100:115], v[60:63], v[172:175], v[100:115]
    s_waitcnt lgkmcnt(0)
    v_mfma_f32_32x32x16_bf16 v[100:115], v[64:67], v[176:179], v[100:115]
    v_sub_u32 v30, 31, v28
    v_lshlrev_b32 v30, 4, v30
    v_add_u32 v30, s55, v30
    v_sub_u32 v37, 1, v29
    v_lshl_add_u32 v31, v37, 10, v30
    v_lshl_add_u32 v30, v37, 9, v30
    v_lshlrev_b32 v38, 2, v1
    v_add_u32 v38, s55, v38
    v_mov_b32 v36, 0
    v_and_b32 v39, 1, v28
    v_cmp_eq_u32_e64 s[98:99], 1, v39
    ds_write_b32 v38, v36 offset:4096
    ds_write_b32 v38, v36 offset:8316
    v_cvt_pk_bf16_f32 v42, v103, v102
    v_cvt_pk_bf16_f32 v43, v101, v100
    v_cvt_pk_bf16_f32 v40, v106, v105
    v_cvt_pk_bf16_f32 v41, v104, v104
    v_cvt_pk_bf16_f32 v44, v110, v110
    v_cvt_pk_bf16_f32 v45, v109, v109
    v_cvt_pk_bf16_f32 v46, v109, v108
    v_cvt_pk_bf16_f32 v47, v108, v108
    v_permlane32_swap_b32 v42, v40
    v_permlane32_swap_b32 v43, v41
    v_cndmask_b32_e64 v49, v112, v113, s[98:99]
    v_cvt_pk_bf16_f32 v48, v113, v113
    v_cvt_pk_bf16_f32 v49, v113, v49
    v_cvt_pk_bf16_f32 v50, v112, v112
    v_mov_b32 v51, v50
    v_cndmask_b32_e64 v53, v114, v115, s[98:99]
    v_cvt_pk_bf16_f32 v52, v115, v115
    v_cvt_pk_bf16_f32 v53, v115, v53
    v_cvt_pk_bf16_f32 v54, v114, v114
    v_mov_b32 v55, v54
    ds_write_b128 v30, v[40:43] offset:3072
    ds_write_b128 v30, v[44:47] offset:2048
    ds_write_b128 v31, v[48:51] offset:512
    ds_write_b128 v31, v[52:55] offset:0
    v_mov_b32 v56, v41
    v_mov_b32 v57, v42
    v_mov_b32 v58, v43
    v_mov_b32_dpp v59, v40 wave_shr:1 row_mask:0xf bank_mask:0xf
    ds_write_b128 v30, v[56:59] offset:7296
    v_mov_b32 v60, v45
    v_mov_b32 v61, v46
    v_mov_b32 v62, v47
    v_mov_b32_dpp v63, v44 wave_shr:1 row_mask:0xf bank_mask:0xf
    ds_write_b128 v30, v[60:63] offset:6272
    v_mov_b32 v64, v49
    v_mov_b32 v65, v50
    v_mov_b32 v66, v51
    v_mov_b32_dpp v67, v48 wave_shr:1 row_mask:0xf bank_mask:0xf
    ds_write_b128 v31, v[64:67] offset:4736
    v_mov_b32 v68, v53
    v_mov_b32 v69, v54
    v_mov_b32 v70, v55
    v_mov_b32_dpp v71, v52 wave_shr:1 row_mask:0xf bank_mask:0xf
    ds_write_b128 v31, v[68:71] offset:4224
    s_mov_b32 s92, 0x80000000
    s_mov_b32 s93, 0x80000000
    s_mov_b64 exec, s[92:93]
    ds_write_b32 v30, v40 offset:7292
    ds_write_b32 v30, v44 offset:6268
    ds_write_b32 v31, v48 offset:4732
    ds_write_b32 v31, v52 offset:4220
    s_mov_b64 exec, 1
    ds_write_b32 v30, v36 offset:7308
    s_mov_b64 exec, -1
    s_waitcnt vmcnt(0)
    s_branch L_a_p3done
L_a_utab:
    buffer_load_dwordx2 v[12:13], v73, s[64:67], 0 offen offset:0
    buffer_load_dwordx2 v[14:15], v73, s[64:67], 0 offen offset:1024
    buffer_load_dwordx2 v[16:17], v73, s[64:67], 0 offen offset:2048
    buffer_load_dwordx2 v[18:19], v73, s[64:67], 0 offen offset:3072
    s_waitcnt vmcnt(0)
    v_and_b32 v27, 255, v0
    v_lshlrev_b32 v28, 4, v27
    v_add_u32 v28, 127232, v28
    v_mov_b32_dpp v2, v18 wave_shr:1 row_mask:0xf bank_mask:0xf
    v_mov_b32_dpp v3, v19 wave_shr:1 row_mask:0xf bank_mask:0xf
    s_mov_b32 s56, 0x05040100
    s_mov_b32 s57, 0x07060302
    v_perm_b32 v32, v4, v2, s56
    v_perm_b32 v33, v8, v6, s56
    v_perm_b32 v34, v12, v10, s56
    v_perm_b32 v35, v16, v14, s56
    ds_write_b128 v28, v[32:35] offset:0
    v_perm_b32 v36, v6, v4, s56
    v_perm_b32 v37, v10, v8, s56
    v_perm_b32 v38, v14, v12, s56
    v_perm_b32 v39, v18, v16, s56
    ds_write_b128 v28, v[36:39] offset:4640
    v_perm_b32 v40, v4, v2, s57
    v_perm_b32 v41, v8, v6, s57
    v_perm_b32 v42, v12, v10, s57
    v_perm_b32 v43, v16, v14, s57
    ds_write_b128 v28, v[40:43] offset:9280
    v_perm_b32 v44, v6, v4, s57
    v_perm_b32 v45, v10, v8, s57
    v_perm_b32 v46, v14, v12, s57
    v_perm_b32 v47, v18, v16, s57
    ds_write_b128 v28, v[44:47] offset:13920
    v_perm_b32 v32, v5, v3, s56
    v_perm_b32 v33, v9, v7, s56
    v_perm_b32 v34, v13, v11, s56
    v_perm_b32 v35, v17, v15, s56
    ds_write_b128 v28, v[32:35] offset:18560
    v_perm_b32 v36, v7, v5, s56
    v_perm_b32 v37, v11, v9, s56
    v_perm_b32 v38, v15, v13, s56
    v_perm_b32 v39, v19, v17, s56
    ds_write_b128 v28, v[36:39] offset:23200
    v_perm_b32 v40, v5, v3, s57
    v_perm_b32 v41, v9, v7, s57
    v_perm_b32 v42, v13, v11, s57
    v_perm_b32 v43, v17, v15, s57
    ds_write_b128 v28, v[40:43] offset:27840
    v_perm_b32 v44, v7, v5, s57
    v_perm_b32 v45, v11, v9, s57
    v_perm_b32 v46, v15, v13, s57
    v_perm_b32 v47, v19, v17, s57
    ds_write_b128 v28, v[44:47] offset:32480
    v_and_b32 v29, 255, v0
    v_lshrrev_b32 v30, 5, v29
    v_mul_u32_u24 v30, 4640, v30
    v_and_b32 v29, 31, v29
    v_lshl_add_u32 v30, v29, 4, v30
    v_add_u32 v30, 126720, v30
    v_mov_b32 v48, 0
    v_mov_b32 v49, 0
    v_mov_b32 v50, 0
    v_mov_b32 v51, 0
    ds_write_b128 v30, v[48:51]
L_a_p3done:
    s_waitcnt lgkmcnt(0)
    s_barrier
    s_cmp_eq_u32 s48, 0
    s_cbranch_scc0 L_a_nosig
    s_mov_b32 s89, 0
L_a_zpoll:
    v_add_u32_dpp v25, v25, v25 row_shr:1 row_mask:0xf bank_mask:0xf bound_ctrl:0
    s_nop 1
    v_add_u32_dpp v25, v25, v25 row_shr:2 row_mask:0xf bank_mask:0xf bound_ctrl:0
    s_nop 1
    v_add_u32_dpp v25, v25, v25 row_shr:4 row_mask:0xf bank_mask:0xf bound_ctrl:0
    s_nop 0
    v_readlane_b32 s66, v25, 7
    s_nop 0
    s_cmp_eq_u32 s66, 8
    s_cbranch_scc1 L_a_zok
    s_add_u32 s89, s89, 1
    s_cmp_gt_u32 s89, 0x40000
    s_cbranch_scc1 L_a_zok
    s_sleep 4
    global_load_dword v25, v24, s[44:45] sc1
    s_waitcnt vmcnt(0)
    s_branch L_a_zpoll
L_a_zok:
    s_and_b32 s66, s91, 15
    s_lshl_b32 s66, s66, 8
    s_add_u32 s66, s66, 4253696
    v_mov_b32 v24, s66
    v_mov_b32 v25, 1
    s_mov_b64 exec, 1
    global_atomic_add v24, v25, s[46:47] sc1
    s_mov_b64 exec, -1
L_a_nosig:
    ds_read_b64 v[224:225], v129 offset:3584
    ds_read_b64 v[226:227], v129 offset:3592
    ds_read_b128 v[192:195], v128 offset:0
    ds_read_b128 v[196:199], v128 offset:512
    ds_read_b128 v[200:203], v128 offset:1024
    ds_read_b128 v[204:207], v128 offset:1536
    ds_read_b128 v[208:211], v128 offset:2048
    ds_read_b128 v[212:215], v128 offset:2560
    ds_read_b128 v[216:219], v128 offset:3072
    ds_read_b128 v[220:223], v128 offset:3584
    ds_read_b64 v[228:229], v129 offset:3072
    ds_read_b64 v[230:231], v129 offset:3080
    ds_read_b64 v[232:233], v129 offset:2560
    ds_read_b64 v[234:235], v129 offset:2568
    ds_read_b64 v[236:237], v129 offset:2048
    ds_read_b64 v[238:239], v129 offset:2056
    ds_read_b64 v[240:241], v129 offset:1536
    ds_read_b64 v[242:243], v129 offset:1544
    ds_read_b64 v[244:245], v129 offset:1024
    ds_read_b64 v[246:247], v129 offset:1032
    ds_read_b64 v[248:249], v129 offset:512
    ds_read_b64 v[250:251], v129 offset:520
    ds_read_b64 v[252:253], v129 offset:0
    ds_read_b64 v[254:255], v129 offset:8
    v_subrev_u32 v128, 64, v128
    v_subrev_u32 v129, 64, v129
    s_waitcnt lgkmcnt(0)
    v_mfma_f32_16x16x32_bf16 v[32:35], v[224:227], v[192:195], 0
    v_mfma_f32_16x16x32_bf16 v[36:39], v[224:227], v[196:199], 0
    v_mfma_f32_16x16x32_bf16 v[40:43], v[224:227], v[200:203], 0
    ds_read_b64 v[96:97], v129 offset:3584
    v_mfma_f32_16x16x32_bf16 v[44:47], v[224:227], v[204:207], 0
    ds_read_b64 v[98:99], v129 offset:3592
    v_mfma_f32_16x16x32_bf16 v[48:51], v[224:227], v[208:211], 0
    ds_read_b128 v[64:67], v128 offset:0
    v_mfma_f32_16x16x32_bf16 v[52:55], v[224:227], v[212:215], 0
    ds_read_b128 v[68:71], v128 offset:512
    v_mfma_f32_16x16x32_bf16 v[56:59], v[224:227], v[216:219], 0
    ds_read_b128 v[72:75], v128 offset:1024
    v_mfma_f32_16x16x32_bf16 v[60:63], v[224:227], v[220:223], 0
    ds_read_b128 v[76:79], v128 offset:1536
    v_mfma_f32_16x16x32_bf16 v[36:39], v[228:231], v[192:195], v[36:39]
    ds_read_b128 v[80:83], v128 offset:2048
    v_mfma_f32_16x16x32_bf16 v[40:43], v[228:231], v[196:199], v[40:43]
    ds_read_b128 v[84:87], v128 offset:2560
    v_mfma_f32_16x16x32_bf16 v[44:47], v[228:231], v[200:203], v[44:47]
    ds_read_b128 v[88:91], v128 offset:3072
    v_mfma_f32_16x16x32_bf16 v[48:51], v[228:231], v[204:207], v[48:51]
    ds_read_b128 v[92:95], v128 offset:3584
    v_mfma_f32_16x16x32_bf16 v[52:55], v[228:231], v[208:211], v[52:55]
    ds_read_b64 v[100:101], v129 offset:3072
    v_mfma_f32_16x16x32_bf16 v[56:59], v[228:231], v[212:215], v[56:59]
    ds_read_b64 v[102:103], v129 offset:3080
    v_mfma_f32_16x16x32_bf16 v[60:63], v[228:231], v[216:219], v[60:63]
    ds_read_b64 v[104:105], v129 offset:2560
    v_mfma_f32_16x16x32_bf16 v[40:43], v[232:235], v[192:195], v[40:43]
    ds_read_b64 v[106:107], v129 offset:2568
    v_mfma_f32_16x16x32_bf16 v[44:47], v[232:235], v[196:199], v[44:47]
    ds_read_b64 v[108:109], v129 offset:2048
    v_mfma_f32_16x16x32_bf16 v[48:51], v[232:235], v[200:203], v[48:51]
    ds_read_b64 v[110:111], v129 offset:2056
    v_mfma_f32_16x16x32_bf16 v[52:55], v[232:235], v[204:207], v[52:55]
    ds_read_b64 v[112:113], v129 offset:1536
    v_mfma_f32_16x16x32_bf16 v[56:59], v[232:235], v[208:211], v[56:59]
    ds_read_b64 v[114:115], v129 offset:1544
    v_mfma_f32_16x16x32_bf16 v[60:63], v[232:235], v[212:215], v[60:63]
    ds_read_b64 v[116:117], v129 offset:1024
    v_mfma_f32_16x16x32_bf16 v[44:47], v[236:239], v[192:195], v[44:47]
    ds_read_b64 v[118:119], v129 offset:1032
    v_mfma_f32_16x16x32_bf16 v[48:51], v[236:239], v[196:199], v[48:51]
    ds_read_b64 v[120:121], v129 offset:512
    v_mfma_f32_16x16x32_bf16 v[52:55], v[236:239], v[200:203], v[52:55]
    ds_read_b64 v[122:123], v129 offset:520
    v_mfma_f32_16x16x32_bf16 v[56:59], v[236:239], v[204:207], v[56:59]
    ds_read_b64 v[124:125], v129 offset:0
    v_mfma_f32_16x16x32_bf16 v[60:63], v[236:239], v[208:211], v[60:63]
    ds_read_b64 v[126:127], v129 offset:8
    v_mfma_f32_16x16x32_bf16 v[48:51], v[240:243], v[192:195], v[48:51]
    v_mfma_f32_16x16x32_bf16 v[52:55], v[240:243], v[196:199], v[52:55]
    v_mfma_f32_16x16x32_bf16 v[56:59], v[240:243], v[200:203], v[56:59]
    v_mfma_f32_16x16x32_bf16 v[60:63], v[240:243], v[204:207], v[60:63]
    v_mfma_f32_16x16x32_bf16 v[52:55], v[244:247], v[192:195], v[52:55]
    v_mfma_f32_16x16x32_bf16 v[56:59], v[244:247], v[196:199], v[56:59]
    v_mfma_f32_16x16x32_bf16 v[60:63], v[244:247], v[200:203], v[60:63]
    v_mfma_f32_16x16x32_bf16 v[56:59], v[248:251], v[192:195], v[56:59]
    v_mfma_f32_16x16x32_bf16 v[60:63], v[248:251], v[196:199], v[60:63]
    v_mfma_f32_16x16x32_bf16 v[60:63], v[252:255], v[192:195], v[60:63]
    v_subrev_u32 v128, 64, v128
    v_subrev_u32 v129, 64, v129
    s_waitcnt lgkmcnt(0)
    v_mfma_f32_16x16x32_bf16 v[32:35], v[96:99], v[64:67], v[32:35]
    v_mfma_f32_16x16x32_bf16 v[36:39], v[96:99], v[68:71], v[36:39]
    v_mfma_f32_16x16x32_bf16 v[40:43], v[96:99], v[72:75], v[40:43]
    ds_read_b64 v[224:225], v129 offset:3584
    v_mfma_f32_16x16x32_bf16 v[44:47], v[96:99], v[76:79], v[44:47]
    ds_read_b64 v[226:227], v129 offset:3592
    v_mfma_f32_16x16x32_bf16 v[48:51], v[96:99], v[80:83], v[48:51]
    ds_read_b128 v[192:195], v128 offset:0
    v_mfma_f32_16x16x32_bf16 v[52:55], v[96:99], v[84:87], v[52:55]
    ds_read_b128 v[196:199], v128 offset:512
    v_mfma_f32_16x16x32_bf16 v[56:59], v[96:99], v[88:91], v[56:59]
    ds_read_b128 v[200:203], v128 offset:1024
    v_mfma_f32_16x16x32_bf16 v[60:63], v[96:99], v[92:95], v[60:63]
    ds_read_b128 v[204:207], v128 offset:1536
    v_mfma_f32_16x16x32_bf16 v[36:39], v[100:103], v[64:67], v[36:39]
    ds_read_b128 v[208:211], v128 offset:2048
    v_mfma_f32_16x16x32_bf16 v[40:43], v[100:103], v[68:71], v[40:43]
    ds_read_b128 v[212:215], v128 offset:2560
    v_mfma_f32_16x16x32_bf16 v[44:47], v[100:103], v[72:75], v[44:47]
    ds_read_b128 v[216:219], v128 offset:3072
    v_mfma_f32_16x16x32_bf16 v[48:51], v[100:103], v[76:79], v[48:51]
    ds_read_b128 v[220:223], v128 offset:3584
    v_mfma_f32_16x16x32_bf16 v[52:55], v[100:103], v[80:83], v[52:55]
    ds_read_b64 v[228:229], v129 offset:3072
    v_mfma_f32_16x16x32_bf16 v[56:59], v[100:103], v[84:87], v[56:59]
    ds_read_b64 v[230:231], v129 offset:3080
    v_mfma_f32_16x16x32_bf16 v[60:63], v[100:103], v[88:91], v[60:63]
    ds_read_b64 v[232:233], v129 offset:2560
    v_mfma_f32_16x16x32_bf16 v[40:43], v[104:107], v[64:67], v[40:43]
    ds_read_b64 v[234:235], v129 offset:2568
    v_mfma_f32_16x16x32_bf16 v[44:47], v[104:107], v[68:71], v[44:47]
    ds_read_b64 v[236:237], v129 offset:2048
    v_mfma_f32_16x16x32_bf16 v[48:51], v[104:107], v[72:75], v[48:51]
    ds_read_b64 v[238:239], v129 offset:2056
    v_mfma_f32_16x16x32_bf16 v[52:55], v[104:107], v[76:79], v[52:55]
    ds_read_b64 v[240:241], v129 offset:1536
    v_mfma_f32_16x16x32_bf16 v[56:59], v[104:107], v[80:83], v[56:59]
    ds_read_b64 v[242:243], v129 offset:1544
    v_mfma_f32_16x16x32_bf16 v[60:63], v[104:107], v[84:87], v[60:63]
    ds_read_b64 v[244:245], v129 offset:1024
    v_mfma_f32_16x16x32_bf16 v[44:47], v[108:111], v[64:67], v[44:47]
    ds_read_b64 v[246:247], v129 offset:1032
    v_mfma_f32_16x16x32_bf16 v[48:51], v[108:111], v[68:71], v[48:51]
    ds_read_b64 v[248:249], v129 offset:512
    v_mfma_f32_16x16x32_bf16 v[52:55], v[108:111], v[72:75], v[52:55]
    ds_read_b64 v[250:251], v129 offset:520
    v_mfma_f32_16x16x32_bf16 v[56:59], v[108:111], v[76:79], v[56:59]
    ds_read_b64 v[252:253], v129 offset:0
    v_mfma_f32_16x16x32_bf16 v[60:63], v[108:111], v[80:83], v[60:63]
    ds_read_b64 v[254:255], v129 offset:8
    v_mfma_f32_16x16x32_bf16 v[48:51], v[112:115], v[64:67], v[48:51]
    v_mfma_f32_16x16x32_bf16 v[52:55], v[112:115], v[68:71], v[52:55]
    v_mfma_f32_16x16x32_bf16 v[56:59], v[112:115], v[72:75], v[56:59]
    v_mfma_f32_16x16x32_bf16 v[60:63], v[112:115], v[76:79], v[60:63]
    v_mfma_f32_16x16x32_bf16 v[52:55], v[116:119], v[64:67], v[52:55]
    v_mfma_f32_16x16x32_bf16 v[56:59], v[116:119], v[68:71], v[56:59]
    v_mfma_f32_16x16x32_bf16 v[60:63], v[116:119], v[72:75], v[60:63]
    v_mfma_f32_16x16x32_bf16 v[56:59], v[120:123], v[64:67], v[56:59]
    v_mfma_f32_16x16x32_bf16 v[60:63], v[120:123], v[68:71], v[60:63]
    v_mfma_f32_16x16x32_bf16 v[60:63], v[124:127], v[64:67], v[60:63]
    s_cmp_eq_u32 s48, 0
    s_cbranch_scc0 L_a_nowc
    global_load_dword v3, v136, s[46:47] sc1
L_a_nowc:
    v_subrev_u32 v128, 64, v128
    v_subrev_u32 v129, 64, v129
    s_waitcnt lgkmcnt(0)
    v_mfma_f32_16x16x32_bf16 v[32:35], v[224:227], v[192:195], v[32:35]
    v_mfma_f32_16x16x32_bf16 v[36:39], v[224:227], v[196:199], v[36:39]
    v_mfma_f32_16x16x32_bf16 v[40:43], v[224:227], v[200:203], v[40:43]
    ds_read_b64 v[96:97], v129 offset:3584
    v_mfma_f32_16x16x32_bf16 v[44:47], v[224:227], v[204:207], v[44:47]
    ds_read_b64 v[98:99], v129 offset:3592
    v_mfma_f32_16x16x32_bf16 v[48:51], v[224:227], v[208:211], v[48:51]
    ds_read_b128 v[64:67], v128 offset:0
    v_mfma_f32_16x16x32_bf16 v[52:55], v[224:227], v[212:215], v[52:55]
    ds_read_b128 v[68:71], v128 offset:512
    v_mfma_f32_16x16x32_bf16 v[56:59], v[224:227], v[216:219], v[56:59]
    ds_read_b128 v[72:75], v128 offset:1024
    v_mfma_f32_16x16x32_bf16 v[60:63], v[224:227], v[220:223], v[60:63]
    ds_read_b128 v[76:79], v128 offset:1536
    v_mfma_f32_16x16x32_bf16 v[36:39], v[228:231], v[192:195], v[36:39]
    ds_read_b128 v[80:83], v128 offset:2048
    v_mfma_f32_16x16x32_bf16 v[40:43], v[228:231], v[196:199], v[40:43]
    ds_read_b128 v[84:87], v128 offset:2560
    v_mfma_f32_16x16x32_bf16 v[44:47], v[228:231], v[200:203], v[44:47]
    ds_read_b128 v[88:91], v128 offset:3072
    v_mfma_f32_16x16x32_bf16 v[48:51], v[228:231], v[204:207], v[48:51]
    ds_read_b128 v[92:95], v128 offset:3584
    v_mfma_f32_16x16x32_bf16 v[52:55], v[228:231], v[208:211], v[52:55]
    ds_read_b64 v[100:101], v129 offset:3072
    v_mfma_f32_16x16x32_bf16 v[56:59], v[228:231], v[212:215], v[56:59]
    ds_read_b64 v[102:103], v129 offset:3080
    v_mfma_f32_16x16x32_bf16 v[60:63], v[228:231], v[216:219], v[60:63]
    ds_read_b64 v[104:105], v129 offset:2560
    v_mfma_f32_16x16x32_bf16 v[40:43], v[232:235], v[192:195], v[40:43]
    ds_read_b64 v[106:107], v129 offset:2568
    v_mfma_f32_16x16x32_bf16 v[44:47], v[232:235], v[196:199], v[44:47]
    ds_read_b64 v[108:109], v129 offset:2048
    v_mfma_f32_16x16x32_bf16 v[48:51], v[232:235], v[200:203], v[48:51]
    ds_read_b64 v[110:111], v129 offset:2056
    v_mfma_f32_16x16x32_bf16 v[52:55], v[232:235], v[204:207], v[52:55]
    ds_read_b64 v[112:113], v129 offset:1536
    v_mfma_f32_16x16x32_bf16 v[56:59], v[232:235], v[208:211], v[56:59]
    ds_read_b64 v[114:115], v129 offset:1544
    v_mfma_f32_16x16x32_bf16 v[60:63], v[232:235], v[212:215], v[60:63]
    ds_read_b64 v[116:117], v129 offset:1024
    v_mfma_f32_16x16x32_bf16 v[44:47], v[236:239], v[192:195], v[44:47]
    ds_read_b64 v[118:119], v129 offset:1032
    v_mfma_f32_16x16x32_bf16 v[48:51], v[236:239], v[196:199], v[48:51]
    ds_read_b64 v[120:121], v129 offset:512
    v_mfma_f32_16x16x32_bf16 v[52:55], v[236:239], v[200:203], v[52:55]
    ds_read_b64 v[122:123], v129 offset:520
    v_mfma_f32_16x16x32_bf16 v[56:59], v[236:239], v[204:207], v[56:59]
    ds_read_b64 v[124:125], v129 offset:0
    v_mfma_f32_16x16x32_bf16 v[60:63], v[236:239], v[208:211], v[60:63]
    ds_read_b64 v[126:127], v129 offset:8
    v_mfma_f32_16x16x32_bf16 v[48:51], v[240:243], v[192:195], v[48:51]
    v_mfma_f32_16x16x32_bf16 v[52:55], v[240:243], v[196:199], v[52:55]
    v_mfma_f32_16x16x32_bf16 v[56:59], v[240:243], v[200:203], v[56:59]
    v_mfma_f32_16x16x32_bf16 v[60:63], v[240:243], v[204:207], v[60:63]
    v_mfma_f32_16x16x32_bf16 v[52:55], v[244:247], v[192:195], v[52:55]
    v_mfma_f32_16x16x32_bf16 v[56:59], v[244:247], v[196:199], v[56:59]
    v_mfma_f32_16x16x32_bf16 v[60:63], v[244:247], v[200:203], v[60:63]
    v_mfma_f32_16x16x32_bf16 v[56:59], v[248:251], v[192:195], v[56:59]
    v_mfma_f32_16x16x32_bf16 v[60:63], v[248:251], v[196:199], v[60:63]
    v_mfma_f32_16x16x32_bf16 v[60:63], v[252:255], v[192:195], v[60:63]
    s_cmp_eq_u32 s52, 1
    s_cbranch_scc1 L_a_clast
L_a_clast:
    s_waitcnt lgkmcnt(0)
    v_mfma_f32_16x16x32_bf16 v[32:35], v[96:99], v[64:67], v[32:35]
    v_mfma_f32_16x16x32_bf16 v[36:39], v[96:99], v[68:71], v[36:39]
    v_mfma_f32_16x16x32_bf16 v[40:43], v[96:99], v[72:75], v[40:43]
    ds_read_b128 v[192:195], v132 offset:0
    v_mfma_f32_16x16x32_bf16 v[44:47], v[96:99], v[76:79], v[44:47]
    ds_read_b128 v[196:199], v132 offset:512
    v_mfma_f32_16x16x32_bf16 v[48:51], v[96:99], v[80:83], v[48:51]
    ds_read_b128 v[200:203], v132 offset:1024
    v_mfma_f32_16x16x32_bf16 v[52:55], v[96:99], v[84:87], v[52:55]
    ds_read_b128 v[204:207], v132 offset:1536
    v_mfma_f32_16x16x32_bf16 v[56:59], v[96:99], v[88:91], v[56:59]
    v_mfma_f32_16x16x32_bf16 v[60:63], v[96:99], v[92:95], v[60:63]
    v_mfma_f32_16x16x32_bf16 v[36:39], v[100:103], v[64:67], v[36:39]
    v_mfma_f32_16x16x32_bf16 v[40:43], v[100:103], v[68:71], v[40:43]
    v_mfma_f32_16x16x32_bf16 v[44:47], v[100:103], v[72:75], v[44:47]
    v_mfma_f32_16x16x32_bf16 v[48:51], v[100:103], v[76:79], v[48:51]
    v_mfma_f32_16x16x32_bf16 v[52:55], v[100:103], v[80:83], v[52:55]
    v_mfma_f32_16x16x32_bf16 v[56:59], v[100:103], v[84:87], v[56:59]
    v_mfma_f32_16x16x32_bf16 v[60:63], v[100:103], v[88:91], v[60:63]
    s_waitcnt lgkmcnt(0)
    v_perm_b32 v192, v192, v192, v133
    v_mfma_f32_16x16x32_bf16 v[40:43], v[104:107], v[64:67], v[40:43]
    v_perm_b32 v193, v193, v193, v133
    v_perm_b32 v194, v194, v194, v133
    v_mfma_f32_16x16x32_bf16 v[44:47], v[104:107], v[68:71], v[44:47]
    v_perm_b32 v195, v195, v195, v133
    v_perm_b32 v196, v196, v196, v133
    v_mfma_f32_16x16x32_bf16 v[48:51], v[104:107], v[72:75], v[48:51]
    v_perm_b32 v197, v197, v197, v133
    v_perm_b32 v198, v198, v198, v133
    v_mfma_f32_16x16x32_bf16 v[52:55], v[104:107], v[76:79], v[52:55]
    v_perm_b32 v199, v199, v199, v133
    v_perm_b32 v200, v200, v200, v133
    v_mfma_f32_16x16x32_bf16 v[56:59], v[104:107], v[80:83], v[56:59]
    v_perm_b32 v201, v201, v201, v133
    v_perm_b32 v202, v202, v202, v133
    v_mfma_f32_16x16x32_bf16 v[60:63], v[104:107], v[84:87], v[60:63]
    v_perm_b32 v203, v203, v203, v133
    v_perm_b32 v204, v204, v204, v133
    v_mfma_f32_16x16x32_bf16 v[44:47], v[108:111], v[64:67], v[44:47]
    v_perm_b32 v205, v205, v205, v133
    v_perm_b32 v206, v206, v206, v133
    v_mfma_f32_16x16x32_bf16 v[48:51], v[108:111], v[68:71], v[48:51]
    v_perm_b32 v207, v207, v207, v133
    v_mul_f32 v192, s59, v192
    v_mfma_f32_16x16x32_bf16 v[52:55], v[108:111], v[72:75], v[52:55]
    v_mul_f32 v193, s59, v193
    v_mul_f32 v194, s59, v194
    v_mfma_f32_16x16x32_bf16 v[56:59], v[108:111], v[76:79], v[56:59]
    v_mul_f32 v195, s59, v195
    v_mul_f32 v196, s59, v196
    v_mfma_f32_16x16x32_bf16 v[60:63], v[108:111], v[80:83], v[60:63]
    v_mul_f32 v197, s59, v197
    v_mul_f32 v198, s59, v198
    v_mfma_f32_16x16x32_bf16 v[48:51], v[112:115], v[64:67], v[48:51]
    v_mul_f32 v199, s59, v199
    v_mul_f32 v200, s59, v200
    v_mfma_f32_16x16x32_bf16 v[52:55], v[112:115], v[68:71], v[52:55]
    v_mul_f32 v201, s59, v201
    v_mul_f32 v202, s59, v202
    v_mfma_f32_16x16x32_bf16 v[56:59], v[112:115], v[72:75], v[56:59]
    v_mul_f32 v203, s59, v203
    v_mul_f32 v204, s59, v204
    v_mfma_f32_16x16x32_bf16 v[60:63], v[112:115], v[76:79], v[60:63]
    v_mul_f32 v205, s59, v205
    v_mul_f32 v206, s59, v206
    v_mfma_f32_16x16x32_bf16 v[52:55], v[116:119], v[64:67], v[52:55]
    v_mul_f32 v207, s59, v207
    v_mfma_f32_16x16x32_bf16 v[56:59], v[116:119], v[68:71], v[56:59]
    v_mfma_f32_16x16x32_bf16 v[60:63], v[116:119], v[72:75], v[60:63]
    v_mfma_f32_16x16x32_bf16 v[56:59], v[120:123], v[64:67], v[56:59]
    v_mfma_f32_16x16x32_bf16 v[60:63], v[120:123], v[68:71], v[60:63]
    v_mfma_f32_16x16x32_bf16 v[60:63], v[124:127], v[64:67], v[60:63]
    s_cmp_eq_u32 s52, 0
    s_cbranch_scc0 L_a_x1
    ds_write_b128 v130, v[48:51] offset:8704
    ds_write_b128 v130, v[52:55] offset:9728
    s_nop 1
    ds_write_b128 v130, v[56:59] offset:10752
    s_nop 0
    ds_write_b128 v130, v[60:63] offset:11776
    v_add_f32 v64, v32, v192
    v_add_f32 v65, v33, v193
    v_add_f32 v66, v34, v194
    v_add_f32 v67, v35, v195
    v_add_f32 v68, v36, v196
    v_add_f32 v69, v37, v197
    v_add_f32 v70, v38, v198
    v_add_f32 v71, v39, v199
    v_add_f32 v72, v40, v200
    v_add_f32 v73, v41, v201
    v_add_f32 v74, v42, v202
    v_add_f32 v75, v43, v203
    v_add_f32 v76, v44, v204
    v_add_f32 v77, v45, v205
    v_add_f32 v78, v46, v206
    v_add_f32 v79, v47, v207
    s_cmp_eq_u32 s48, 0
    s_cbranch_scc0 L_a_wc
    s_waitcnt vmcnt(0)
    s_mov_b32 s89, 0
L_a_wfpoll:
    v_add_u32_dpp v3, v3, v3 row_shr:1 row_mask:0xf bank_mask:0xf bound_ctrl:0
    s_nop 1
    v_add_u32_dpp v3, v3, v3 row_shr:2 row_mask:0xf bank_mask:0xf bound_ctrl:0
    s_nop 1
    v_add_u32_dpp v3, v3, v3 row_shr:4 row_mask:0xf bank_mask:0xf bound_ctrl:0
    s_nop 1
    v_add_u32_dpp v3, v3, v3 row_shr:8 row_mask:0xf bank_mask:0xf bound_ctrl:0
    s_nop 0
    v_readlane_b32 s66, v3, 15
    s_nop 0
    s_cmp_eq_u32 s66, 128
    s_cbranch_scc1 L_a_wc
    s_add_u32 s89, s89, 1
    s_cmp_gt_u32 s89, 0x40000
    s_cbranch_scc1 L_a_wc
    s_sleep 8
    global_load_dword v3, v136, s[46:47] sc1
    s_waitcnt vmcnt(0)
    s_branch L_a_wfpoll
L_a_wc:
    s_waitcnt lgkmcnt(0)
    s_barrier
    ds_read_b128 v[96:99], v130 offset:12800
    ds_read_b128 v[100:103], v130 offset:13824
    ds_read_b128 v[104:107], v130 offset:14848
    ds_read_b128 v[108:111], v130 offset:15872
    s_branch L_a_x2
L_a_x1:
    ds_write_b128 v130, v[32:35] offset:12800
    ds_write_b128 v130, v[36:39] offset:13824
    ds_write_b128 v130, v[40:43] offset:14848
    ds_write_b128 v130, v[44:47] offset:15872
    v_add_f32 v64, v48, v192
    v_add_f32 v65, v49, v193
    v_add_f32 v66, v50, v194
    v_add_f32 v67, v51, v195
    v_add_f32 v68, v52, v196
    v_add_f32 v69, v53, v197
    v_add_f32 v70, v54, v198
    v_add_f32 v71, v55, v199
    v_add_f32 v72, v56, v200
    v_add_f32 v73, v57, v201
    v_add_f32 v74, v58, v202
    v_add_f32 v75, v59, v203
    v_add_f32 v76, v60, v204
    v_add_f32 v77, v61, v205
    v_add_f32 v78, v62, v206
    v_add_f32 v79, v63, v207
    s_waitcnt lgkmcnt(0)
    s_barrier
    ds_read_b128 v[96:99], v130 offset:8704
    ds_read_b128 v[100:103], v130 offset:9728
    ds_read_b128 v[104:107], v130 offset:10752
    ds_read_b128 v[108:111], v130 offset:11776
L_a_x2:
    s_waitcnt lgkmcnt(2)
    v_add_f32 v64, v64, v96
    v_add_f32 v65, v65, v97
    v_add_f32 v66, v66, v98
    v_add_f32 v67, v67, v99
    v_add_f32 v68, v68, v100
    v_add_f32 v69, v69, v101
    v_add_f32 v70, v70, v102
    v_add_f32 v71, v71, v103
    v_cvt_pk_bf16_f32 v208, v64, v65
    v_cvt_pk_bf16_f32 v209, v66, v67
    v_cvt_pk_bf16_f32 v210, v68, v69
    v_cvt_pk_bf16_f32 v211, v70, v71
    v_cndmask_b32_e64 v212, v210, v208, s[8:9]
    v_cndmask_b32_e64 v213, v211, v209, s[8:9]
    v_cndmask_b32_e64 v214, v208, v210, s[8:9]
    v_cndmask_b32_e64 v215, v209, v211, s[8:9]
    v_mov_b32_dpp v216, v212 quad_perm:[1,0,3,2] row_mask:0xf bank_mask:0xf
    v_mov_b32_dpp v217, v213 quad_perm:[1,0,3,2] row_mask:0xf bank_mask:0xf
    v_perm_b32 v240, v216, v214, v134
    v_perm_b32 v241, v216, v214, v135
    v_perm_b32 v242, v217, v215, v134
    v_perm_b32 v243, v217, v215, v135
    global_store_dwordx4 v131, v[240:243], s[46:47] offset:0 sc1
    s_waitcnt lgkmcnt(0)
    v_add_f32 v72, v72, v104
    v_add_f32 v73, v73, v105
    v_add_f32 v74, v74, v106
    v_add_f32 v75, v75, v107
    v_add_f32 v76, v76, v108
    v_add_f32 v77, v77, v109
    v_add_f32 v78, v78, v110
    v_add_f32 v79, v79, v111
    v_cvt_pk_bf16_f32 v224, v72, v73
    v_cvt_pk_bf16_f32 v225, v74, v75
    v_cvt_pk_bf16_f32 v226, v76, v77
    v_cvt_pk_bf16_f32 v227, v78, v79
    v_cndmask_b32_e64 v228, v226, v224, s[8:9]
    v_cndmask_b32_e64 v229, v227, v225, s[8:9]
    v_cndmask_b32_e64 v230, v224, v226, s[8:9]
    v_cndmask_b32_e64 v231, v225, v227, s[8:9]
    v_mov_b32_dpp v232, v228 quad_perm:[1,0,3,2] row_mask:0xf bank_mask:0xf
    v_mov_b32_dpp v233, v229 quad_perm:[1,0,3,2] row_mask:0xf bank_mask:0xf
    v_perm_b32 v244, v232, v230, v134
    v_perm_b32 v245, v232, v230, v135
    v_perm_b32 v246, v233, v231, v134
    v_perm_b32 v247, v233, v231, v135
    global_store_dwordx4 v131, v[244:247], s[46:47] offset:1024 sc1
    s_branch L_k1_fin
L_roleB:
    s_and_b32 s55, s49, 3
    s_lshl_b32 s51, s55, 2
    s_and_b32 s55, s50, 3
    s_add_u32 s51, s51, s55
    s_lshr_b32 s55, s49, 2
    s_lshl_b32 s52, s55, 2
    s_lshr_b32 s55, s50, 2
    s_add_u32 s52, s52, s55
    s_and_b32 s53, s48, 3
    s_lshr_b32 s54, s48, 2
    s_and_b32 s91, s50, 3
    s_lshl_b32 s91, s91, 1
    s_and_b32 s55, s49, 1
    s_add_u32 s91, s91, s55
    s_sub_u32 s95, s52, s91
    s_and_b32 s95, s95, 7
    v_lshrrev_b32 v12, 3, v1
    v_and_b32 v13, 7, v1
    v_lshrrev_b32 v14, 1, v12
    v_xor_b32 v14, v14, v13
    s_lshl_b32 s55, s51, 7
    s_lshl_b32 s64, s48, 4
    s_add_u32 s55, s55, s64
    v_add_u32 v15, s55, v12
    v_lshlrev_b32 v15, 10, v15
    v_lshl_add_u32 v8, v14, 4, v15
    v_xor_b32 v14, 4, v14
    v_lshl_add_u32 v9, v14, 4, v15
    v_add_u32 v9, 8192, v9
    v_bfe_u32 v14, v1, 4, 1
    v_lshlrev_b32 v14, 2, v14
    v_xor_b32 v14, v14, v13
    s_lshl_b32 s55, s48, 3
    v_add_u32 v15, s55, v12
    v_mul_u32_u24 v15, 3072, v15
    v_lshl_add_u32 v10, v14, 4, v15
    s_lshl_b32 s55, s52, 7
    v_add_u32 v10, s55, v10
    v_and_b32 v15, 3, v0
    v_lshlrev_b32 v15, 5, v15
    s_lshl_b32 s55, s52, 7
    v_add_u32 v15, s55, v15
    s_lshl_b32 s88, s48, 10
    s_lshl_b32 s89, s48, 11
    s_waitcnt lgkmcnt(0)
    s_mov_b32 s56, s16
    s_mov_b32 s57, s17
    s_mov_b32 s58, 2097152
    s_mov_b32 s59, 0x20000
    s_mov_b32 s60, s36
    s_mov_b32 s61, s37
    s_mov_b32 s62, 1572864
    s_mov_b32 s63, 0x20000
    global_load_dwordx4 v[112:115], v15, s[40:41]
    global_load_dwordx4 v[116:119], v15, s[40:41] offset:16
    s_add_u32 s55, s91, 0
    s_and_b32 s55, s55, 7
    s_lshl_b32 s66, s55, 7
    s_mul_i32 s67, s55, 196608
    s_add_u32 m0, s89, 0
    s_nop 0
    buffer_load_dwordx4 v8, s[56:59], s66 offen lds
    s_add_u32 m0, s89, 1024
    s_nop 0
    buffer_load_dwordx4 v9, s[56:59], s66 offen lds
    s_add_u32 s64, s67, 1024
    s_add_u32 m0, s88, 16384
    s_nop 0
    buffer_load_dwordx4 v10, s[60:63], s64 offen lds
    s_add_u32 s64, s67, 2048
    s_add_u32 m0, s88, 24576
    s_nop 0
    buffer_load_dwordx4 v10, s[60:63], s64 offen lds
    s_barrier
    s_add_u32 s55, s91, 1
    s_and_b32 s55, s55, 7
    s_lshl_b32 s66, s55, 7
    s_mul_i32 s67, s55, 196608
    s_add_u32 m0, s89, 32768
    s_nop 0
    buffer_load_dwordx4 v8, s[56:59], s66 offen lds
    s_add_u32 m0, s89, 33792
    s_nop 0
    buffer_load_dwordx4 v9, s[56:59], s66 offen lds
    s_add_u32 s64, s67, 1024
    s_add_u32 m0, s88, 49152
    s_nop 0
    buffer_load_dwordx4 v10, s[60:63], s64 offen lds
    s_add_u32 s64, s67, 2048
    s_add_u32 m0, s88, 57344
    s_nop 0
    buffer_load_dwordx4 v10, s[60:63], s64 offen lds
    v_and_b32 v12, 31, v1
    s_lshl_b32 s55, s53, 5
    v_add_u32 v12, s55, v12
    v_lshrrev_b32 v13, 5, v1
    v_bfe_u32 v14, v12, 1, 3
    v_xor_b32 v14, v14, v13
    v_lshlrev_b32 v14, 4, v14
    v_lshl_add_u32 v2, v12, 7, v14
    v_xor_b32 v3, 32, v2
    v_xor_b32 v4, 64, v2
    v_xor_b32 v5, 96, v2
    v_and_b32 v12, 15, v1
    v_lshrrev_b32 v14, 2, v12
    v_lshl_add_u32 v15, v13, 3, v14
    v_lshlrev_b32 v15, 7, v15
    v_bfe_u32 v7, v1, 4, 1
    v_lshlrev_b32 v7, 1, v7
    s_lshl_b32 s55, s54, 2
    v_add_u32 v7, s55, v7
    v_bfe_u32 v13, v12, 1, 1
    v_add_u32 v7, v7, v13
    v_bfe_u32 v13, v14, 1, 1
    v_lshlrev_b32 v13, 2, v13
    v_xor_b32 v7, v7, v13
    v_lshl_add_u32 v15, v7, 4, v15
    v_and_b32 v13, 1, v12
    v_lshl_add_u32 v6, v13, 3, v15
    s_mov_b32 s82, 1069066811
    s_mov_b32 s83, 1069066811
    s_mov_b32 s84, 0x358637bd
    s_mov_b32 s85, 0x358637bd
    s_add_u32 s86, s46, 4194304
    s_addc_u32 s87, s47, 0
    v_lshrrev_b32 v12, 2, v0
    v_and_b32 v13, 3, v0
    v_lshlrev_b32 v13, 1, v13
    v_bfe_u32 v14, v12, 1, 3
    v_xor_b32 v13, v13, v14
    v_lshlrev_b32 v13, 4, v13
    v_lshl_add_u32 v12, v12, 7, v13
    v_xor_b32 v13, 16, v12
    s_waitcnt vmcnt(4)
    s_barrier
    ds_read_b128 v[128:131], v2 offset:0
    ds_read_b64_tr_b16 v[48:49], v6 offset:16384
    ds_read_b64_tr_b16 v[50:51], v6 offset:16896
    ds_read_b64_tr_b16 v[52:53], v6 offset:24576
    ds_read_b64_tr_b16 v[54:55], v6 offset:25088
    ds_read_b128 v[132:135], v3 offset:0
    ds_read_b64_tr_b16 v[56:57], v6 offset:18432
    ds_read_b64_tr_b16 v[58:59], v6 offset:18944
    ds_read_b64_tr_b16 v[60:61], v6 offset:26624
    ds_read_b64_tr_b16 v[62:63], v6 offset:27136
    ds_read_b128 v[136:139], v4 offset:0
    ds_read_b64_tr_b16 v[64:65], v6 offset:20480
    ds_read_b64_tr_b16 v[66:67], v6 offset:20992
    ds_read_b64_tr_b16 v[68:69], v6 offset:28672
    ds_read_b64_tr_b16 v[70:71], v6 offset:29184
    ds_read_b128 v[140:143], v5 offset:0
    ds_read_b64_tr_b16 v[72:73], v6 offset:22528
    ds_read_b64_tr_b16 v[74:75], v6 offset:23040
    ds_read_b64_tr_b16 v[76:77], v6 offset:30720
    ds_read_b64_tr_b16 v[78:79], v6 offset:31232
    s_cmp_eq_u32 s95, 0
    s_cbranch_scc0 L_b_gr0
    ds_read_b128 v[120:123], v12 offset:0
    ds_read_b128 v[124:127], v13 offset:0
L_b_gr0:
    s_add_u32 s55, s91, 2
    s_and_b32 s55, s55, 7
    s_lshl_b32 s66, s55, 7
    s_mul_i32 s67, s55, 196608
    s_add_u32 m0, s89, 65536
    s_nop 0
    buffer_load_dwordx4 v8, s[56:59], s66 offen lds
    s_add_u32 m0, s89, 66560
    s_nop 0
    buffer_load_dwordx4 v9, s[56:59], s66 offen lds
    s_add_u32 s64, s67, 1024
    s_add_u32 m0, s88, 81920
    s_nop 0
    buffer_load_dwordx4 v10, s[60:63], s64 offen lds
    s_add_u32 s64, s67, 2048
    s_add_u32 m0, s88, 90112
    s_nop 0
    buffer_load_dwordx4 v10, s[60:63], s64 offen lds
    s_add_u32 s55, s91, 3
    s_and_b32 s55, s55, 7
    s_lshl_b32 s66, s55, 7
    s_mul_i32 s67, s55, 196608
    s_add_u32 m0, s89, 98304
    s_nop 0
    buffer_load_dwordx4 v8, s[56:59], s66 offen lds
    s_add_u32 m0, s89, 99328
    s_nop 0
    buffer_load_dwordx4 v9, s[56:59], s66 offen lds
    s_add_u32 s64, s67, 1024
    s_add_u32 m0, s88, 114688
    s_nop 0
    buffer_load_dwordx4 v10, s[60:63], s64 offen lds
    s_add_u32 s64, s67, 2048
    s_add_u32 m0, s88, 122880
    s_nop 0
    buffer_load_dwordx4 v10, s[60:63], s64 offen lds
    s_waitcnt lgkmcnt(0)
    s_waitcnt vmcnt(8)
    s_barrier
    v_mfma_f32_32x32x16_bf16 v[16:31], v[128:131], v[48:51], 0
    ds_read_b128 v[144:147], v2 offset:32768
    ds_read_b64_tr_b16 v[80:81], v6 offset:49152
    ds_read_b64_tr_b16 v[82:83], v6 offset:49664
    v_mfma_f32_32x32x16_bf16 v[32:47], v[128:131], v[52:55], 0
    ds_read_b64_tr_b16 v[84:85], v6 offset:57344
    ds_read_b64_tr_b16 v[86:87], v6 offset:57856
    ds_read_b128 v[148:151], v3 offset:32768
    s_add_u32 s55, s91, 4
    s_and_b32 s55, s55, 7
    s_lshl_b32 s66, s55, 7
    s_mul_i32 s67, s55, 196608
    s_add_u32 m0, s89, 0
    s_nop 0
    buffer_load_dwordx4 v8, s[56:59], s66 offen lds
    v_mfma_f32_32x32x16_bf16 v[16:31], v[132:135], v[56:59], v[16:31]
    ds_read_b64_tr_b16 v[88:89], v6 offset:51200
    ds_read_b64_tr_b16 v[90:91], v6 offset:51712
    ds_read_b64_tr_b16 v[92:93], v6 offset:59392
    v_mfma_f32_32x32x16_bf16 v[32:47], v[132:135], v[60:63], v[32:47]
    ds_read_b64_tr_b16 v[94:95], v6 offset:59904
    ds_read_b128 v[152:155], v4 offset:32768
    ds_read_b64_tr_b16 v[96:97], v6 offset:53248
    s_add_u32 m0, s89, 1024
    s_nop 0
    buffer_load_dwordx4 v9, s[56:59], s66 offen lds
    v_mfma_f32_32x32x16_bf16 v[16:31], v[136:139], v[64:67], v[16:31]
    ds_read_b64_tr_b16 v[98:99], v6 offset:53760
    ds_read_b64_tr_b16 v[100:101], v6 offset:61440
    v_mfma_f32_32x32x16_bf16 v[32:47], v[136:139], v[68:71], v[32:47]
    ds_read_b64_tr_b16 v[102:103], v6 offset:61952
    ds_read_b128 v[156:159], v5 offset:32768
    s_add_u32 s64, s67, 1024
    s_add_u32 m0, s88, 16384
    s_nop 0
    buffer_load_dwordx4 v10, s[60:63], s64 offen lds
    v_mfma_f32_32x32x16_bf16 v[16:31], v[140:143], v[72:75], v[16:31]
    ds_read_b64_tr_b16 v[104:105], v6 offset:55296
    ds_read_b64_tr_b16 v[106:107], v6 offset:55808
    v_mfma_f32_32x32x16_bf16 v[32:47], v[140:143], v[76:79], v[32:47]
    ds_read_b64_tr_b16 v[108:109], v6 offset:63488
    ds_read_b64_tr_b16 v[110:111], v6 offset:64000
    s_add_u32 s64, s67, 2048
    s_add_u32 m0, s88, 24576
    s_nop 0
    buffer_load_dwordx4 v10, s[60:63], s64 offen lds
    s_cmp_eq_u32 s95, 0
    s_cbranch_scc0 L_b_gd0
    v_mov_b32 v11, 0
    v_dot2_f32_bf16 v11, v120, v112, v11
    v_dot2_f32_bf16 v11, v121, v113, v11
    v_dot2_f32_bf16 v11, v122, v114, v11
    v_dot2_f32_bf16 v11, v123, v115, v11
    v_dot2_f32_bf16 v11, v124, v116, v11
    v_dot2_f32_bf16 v11, v125, v117, v11
    v_dot2_f32_bf16 v11, v126, v118, v11
    v_dot2_f32_bf16 v11, v127, v119, v11
L_b_gd0:
    s_cmp_eq_u32 s95, 1
    s_cbranch_scc0 L_b_gr1
    ds_read_b128 v[120:123], v12 offset:32768
    ds_read_b128 v[124:127], v13 offset:32768
L_b_gr1:
    s_waitcnt lgkmcnt(0)
    v_xor_b32 v2, 0x10000, v2
    v_xor_b32 v3, 0x10000, v3
    v_xor_b32 v4, 0x10000, v4
    v_xor_b32 v5, 0x10000, v5
    v_xor_b32 v6, 0x10000, v6
    s_waitcnt vmcnt(8)
    s_barrier
    v_mfma_f32_32x32x16_bf16 v[16:31], v[144:147], v[80:83], v[16:31]
    ds_read_b128 v[160:163], v2 offset:0
    ds_read_b64_tr_b16 v[48:49], v6 offset:16384
    ds_read_b64_tr_b16 v[50:51], v6 offset:16896
    v_mfma_f32_32x32x16_bf16 v[32:47], v[144:147], v[84:87], v[32:47]
    ds_read_b64_tr_b16 v[52:53], v6 offset:24576
    ds_read_b64_tr_b16 v[54:55], v6 offset:25088
    ds_read_b128 v[164:167], v3 offset:0
    s_add_u32 s55, s91, 5
    s_and_b32 s55, s55, 7
    s_lshl_b32 s66, s55, 7
    s_mul_i32 s67, s55, 196608
    s_add_u32 m0, s89, 32768
    s_nop 0
    buffer_load_dwordx4 v8, s[56:59], s66 offen lds
    v_mfma_f32_32x32x16_bf16 v[16:31], v[148:151], v[88:91], v[16:31]
    ds_read_b64_tr_b16 v[56:57], v6 offset:18432
    ds_read_b64_tr_b16 v[58:59], v6 offset:18944
    ds_read_b64_tr_b16 v[60:61], v6 offset:26624
    v_mfma_f32_32x32x16_bf16 v[32:47], v[148:151], v[92:95], v[32:47]
    ds_read_b64_tr_b16 v[62:63], v6 offset:27136
    ds_read_b128 v[168:171], v4 offset:0
    ds_read_b64_tr_b16 v[64:65], v6 offset:20480
    s_add_u32 m0, s89, 33792
    s_nop 0
    buffer_load_dwordx4 v9, s[56:59], s66 offen lds
    v_mfma_f32_32x32x16_bf16 v[16:31], v[152:155], v[96:99], v[16:31]
    ds_read_b64_tr_b16 v[66:67], v6 offset:20992
    ds_read_b64_tr_b16 v[68:69], v6 offset:28672
    v_mfma_f32_32x32x16_bf16 v[32:47], v[152:155], v[100:103], v[32:47]
    ds_read_b64_tr_b16 v[70:71], v6 offset:29184
    ds_read_b128 v[172:175], v5 offset:0
    s_add_u32 s64, s67, 1024
    s_add_u32 m0, s88, 49152
    s_nop 0
    buffer_load_dwordx4 v10, s[60:63], s64 offen lds
    v_mfma_f32_32x32x16_bf16 v[16:31], v[156:159], v[104:107], v[16:31]
    ds_read_b64_tr_b16 v[72:73], v6 offset:22528
    ds_read_b64_tr_b16 v[74:75], v6 offset:23040
    v_mfma_f32_32x32x16_bf16 v[32:47], v[156:159], v[108:111], v[32:47]
    ds_read_b64_tr_b16 v[76:77], v6 offset:30720
    ds_read_b64_tr_b16 v[78:79], v6 offset:31232
    s_add_u32 s64, s67, 2048
    s_add_u32 m0, s88, 57344
    s_nop 0
    buffer_load_dwordx4 v10, s[60:63], s64 offen lds
    s_cmp_eq_u32 s95, 1
    s_cbranch_scc0 L_b_gd1
    v_mov_b32 v11, 0
    v_dot2_f32_bf16 v11, v120, v112, v11
    v_dot2_f32_bf16 v11, v121, v113, v11
    v_dot2_f32_bf16 v11, v122, v114, v11
    v_dot2_f32_bf16 v11, v123, v115, v11
    v_dot2_f32_bf16 v11, v124, v116, v11
    v_dot2_f32_bf16 v11, v125, v117, v11
    v_dot2_f32_bf16 v11, v126, v118, v11
    v_dot2_f32_bf16 v11, v127, v119, v11
L_b_gd1:
    s_cmp_eq_u32 s95, 2
    s_cbranch_scc0 L_b_gr2
    v_add_u32 v12, 65536, v12
    v_add_u32 v13, 65536, v13
    ds_read_b128 v[120:123], v12 offset:0
    ds_read_b128 v[124:127], v13 offset:0
L_b_gr2:
    s_waitcnt lgkmcnt(0)
    s_waitcnt vmcnt(8)
    s_barrier
    v_mfma_f32_32x32x16_bf16 v[16:31], v[160:163], v[48:51], v[16:31]
    ds_read_b128 v[176:179], v2 offset:32768
    ds_read_b64_tr_b16 v[80:81], v6 offset:49152
    ds_read_b64_tr_b16 v[82:83], v6 offset:49664
    v_mfma_f32_32x32x16_bf16 v[32:47], v[160:163], v[52:55], v[32:47]
    ds_read_b64_tr_b16 v[84:85], v6 offset:57344
    ds_read_b64_tr_b16 v[86:87], v6 offset:57856
    ds_read_b128 v[180:183], v3 offset:32768
    s_add_u32 s55, s91, 6
    s_and_b32 s55, s55, 7
    s_lshl_b32 s66, s55, 7
    s_mul_i32 s67, s55, 196608
    s_add_u32 m0, s89, 65536
    s_nop 0
    buffer_load_dwordx4 v8, s[56:59], s66 offen lds
    v_mfma_f32_32x32x16_bf16 v[16:31], v[164:167], v[56:59], v[16:31]
    ds_read_b64_tr_b16 v[88:89], v6 offset:51200
    ds_read_b64_tr_b16 v[90:91], v6 offset:51712
    ds_read_b64_tr_b16 v[92:93], v6 offset:59392
    v_mfma_f32_32x32x16_bf16 v[32:47], v[164:167], v[60:63], v[32:47]
    ds_read_b64_tr_b16 v[94:95], v6 offset:59904
    ds_read_b128 v[184:187], v4 offset:32768
    ds_read_b64_tr_b16 v[96:97], v6 offset:53248
    s_add_u32 m0, s89, 66560
    s_nop 0
    buffer_load_dwordx4 v9, s[56:59], s66 offen lds
    v_mfma_f32_32x32x16_bf16 v[16:31], v[168:171], v[64:67], v[16:31]
    ds_read_b64_tr_b16 v[98:99], v6 offset:53760
    ds_read_b64_tr_b16 v[100:101], v6 offset:61440
    v_mfma_f32_32x32x16_bf16 v[32:47], v[168:171], v[68:71], v[32:47]
    ds_read_b64_tr_b16 v[102:103], v6 offset:61952
    ds_read_b128 v[188:191], v5 offset:32768
    s_add_u32 s64, s67, 1024
    s_add_u32 m0, s88, 81920
    s_nop 0
    buffer_load_dwordx4 v10, s[60:63], s64 offen lds
    v_mfma_f32_32x32x16_bf16 v[16:31], v[172:175], v[72:75], v[16:31]
    ds_read_b64_tr_b16 v[104:105], v6 offset:55296
    ds_read_b64_tr_b16 v[106:107], v6 offset:55808
    v_mfma_f32_32x32x16_bf16 v[32:47], v[172:175], v[76:79], v[32:47]
    ds_read_b64_tr_b16 v[108:109], v6 offset:63488
    ds_read_b64_tr_b16 v[110:111], v6 offset:64000
    s_add_u32 s64, s67, 2048
    s_add_u32 m0, s88, 90112
    s_nop 0
    buffer_load_dwordx4 v10, s[60:63], s64 offen lds
    s_cmp_eq_u32 s95, 2
    s_cbranch_scc0 L_b_gd2
    v_mov_b32 v11, 0
    v_dot2_f32_bf16 v11, v120, v112, v11
    v_dot2_f32_bf16 v11, v121, v113, v11
    v_dot2_f32_bf16 v11, v122, v114, v11
    v_dot2_f32_bf16 v11, v123, v115, v11
    v_dot2_f32_bf16 v11, v124, v116, v11
    v_dot2_f32_bf16 v11, v125, v117, v11
    v_dot2_f32_bf16 v11, v126, v118, v11
    v_dot2_f32_bf16 v11, v127, v119, v11
L_b_gd2:
    s_cmp_eq_u32 s95, 3
    s_cbranch_scc0 L_b_gr3
    v_add_u32 v12, 65536, v12
    v_add_u32 v13, 65536, v13
    ds_read_b128 v[120:123], v12 offset:32768
    ds_read_b128 v[124:127], v13 offset:32768
L_b_gr3:
    s_waitcnt lgkmcnt(0)
    v_xor_b32 v2, 0x10000, v2
    v_xor_b32 v3, 0x10000, v3
    v_xor_b32 v4, 0x10000, v4
    v_xor_b32 v5, 0x10000, v5
    v_xor_b32 v6, 0x10000, v6
    s_waitcnt vmcnt(8)
    s_barrier
    v_mfma_f32_32x32x16_bf16 v[16:31], v[176:179], v[80:83], v[16:31]
    ds_read_b128 v[192:195], v2 offset:0
    ds_read_b64_tr_b16 v[48:49], v6 offset:16384
    ds_read_b64_tr_b16 v[50:51], v6 offset:16896
    v_mfma_f32_32x32x16_bf16 v[32:47], v[176:179], v[84:87], v[32:47]
    ds_read_b64_tr_b16 v[52:53], v6 offset:24576
    ds_read_b64_tr_b16 v[54:55], v6 offset:25088
    ds_read_b128 v[196:199], v3 offset:0
    s_add_u32 s55, s91, 7
    s_and_b32 s55, s55, 7
    s_lshl_b32 s66, s55, 7
    s_mul_i32 s67, s55, 196608
    s_add_u32 m0, s89, 98304
    s_nop 0
    buffer_load_dwordx4 v8, s[56:59], s66 offen lds
    v_mfma_f32_32x32x16_bf16 v[16:31], v[180:183], v[88:91], v[16:31]
    ds_read_b64_tr_b16 v[56:57], v6 offset:18432
    ds_read_b64_tr_b16 v[58:59], v6 offset:18944
    ds_read_b64_tr_b16 v[60:61], v6 offset:26624
    v_mfma_f32_32x32x16_bf16 v[32:47], v[180:183], v[92:95], v[32:47]
    ds_read_b64_tr_b16 v[62:63], v6 offset:27136
    ds_read_b128 v[200:203], v4 offset:0
    ds_read_b64_tr_b16 v[64:65], v6 offset:20480
    s_add_u32 m0, s89, 99328
    s_nop 0
    buffer_load_dwordx4 v9, s[56:59], s66 offen lds
    v_mfma_f32_32x32x16_bf16 v[16:31], v[184:187], v[96:99], v[16:31]
    ds_read_b64_tr_b16 v[66:67], v6 offset:20992
    ds_read_b64_tr_b16 v[68:69], v6 offset:28672
    v_mfma_f32_32x32x16_bf16 v[32:47], v[184:187], v[100:103], v[32:47]
    ds_read_b64_tr_b16 v[70:71], v6 offset:29184
    ds_read_b128 v[204:207], v5 offset:0
    s_add_u32 s64, s67, 1024
    s_add_u32 m0, s88, 114688
    s_nop 0
    buffer_load_dwordx4 v10, s[60:63], s64 offen lds
    v_mfma_f32_32x32x16_bf16 v[16:31], v[188:191], v[104:107], v[16:31]
    ds_read_b64_tr_b16 v[72:73], v6 offset:22528
    ds_read_b64_tr_b16 v[74:75], v6 offset:23040
    v_mfma_f32_32x32x16_bf16 v[32:47], v[188:191], v[108:111], v[32:47]
    ds_read_b64_tr_b16 v[76:77], v6 offset:30720
    ds_read_b64_tr_b16 v[78:79], v6 offset:31232
    s_add_u32 s64, s67, 2048
    s_add_u32 m0, s88, 122880
    s_nop 0
    buffer_load_dwordx4 v10, s[60:63], s64 offen lds
    v_and_b32 v7, 7, v1
    v_lshlrev_b32 v7, 2, v7
    s_cmp_eq_u32 s48, 0
    s_cbranch_scc0 L_b_nodbg3
    global_load_dword v14, v7, s[44:45] sc1
L_b_nodbg3:
    s_cmp_eq_u32 s95, 3
    s_cbranch_scc0 L_b_gd3
    v_mov_b32 v11, 0
    v_dot2_f32_bf16 v11, v120, v112, v11
    v_dot2_f32_bf16 v11, v121, v113, v11
    v_dot2_f32_bf16 v11, v122, v114, v11
    v_dot2_f32_bf16 v11, v123, v115, v11
    v_dot2_f32_bf16 v11, v124, v116, v11
    v_dot2_f32_bf16 v11, v125, v117, v11
    v_dot2_f32_bf16 v11, v126, v118, v11
    v_dot2_f32_bf16 v11, v127, v119, v11
L_b_gd3:
    s_cmp_eq_u32 s95, 4
    s_cbranch_scc0 L_b_gr4
    ds_read_b128 v[120:123], v12 offset:0
    ds_read_b128 v[124:127], v13 offset:0
L_b_gr4:
    s_waitcnt lgkmcnt(0)
    s_waitcnt vmcnt(8)
    s_barrier
    v_mfma_f32_32x32x16_bf16 v[16:31], v[192:195], v[48:51], v[16:31]
    ds_read_b128 v[208:211], v2 offset:32768
    ds_read_b64_tr_b16 v[80:81], v6 offset:49152
    ds_read_b64_tr_b16 v[82:83], v6 offset:49664
    v_mfma_f32_32x32x16_bf16 v[32:47], v[192:195], v[52:55], v[32:47]
    ds_read_b64_tr_b16 v[84:85], v6 offset:57344
    ds_read_b64_tr_b16 v[86:87], v6 offset:57856
    ds_read_b128 v[212:215], v3 offset:32768
    s_add_u32 s55, s91, 0
    s_and_b32 s55, s55, 7
    s_lshl_b32 s66, s55, 7
    s_mul_i32 s67, s55, 196608
    s_add_u32 m0, s88, 0
    s_nop 0
    buffer_load_dwordx4 v10, s[60:63], s67 offen lds
    v_mfma_f32_32x32x16_bf16 v[16:31], v[196:199], v[56:59], v[16:31]
    ds_read_b64_tr_b16 v[88:89], v6 offset:51200
    ds_read_b64_tr_b16 v[90:91], v6 offset:51712
    ds_read_b64_tr_b16 v[92:93], v6 offset:59392
    v_mfma_f32_32x32x16_bf16 v[32:47], v[196:199], v[60:63], v[32:47]
    ds_read_b64_tr_b16 v[94:95], v6 offset:59904
    ds_read_b128 v[216:219], v4 offset:32768
    ds_read_b64_tr_b16 v[96:97], v6 offset:53248
    s_add_u32 s55, s91, 1
    s_and_b32 s55, s55, 7
    s_lshl_b32 s66, s55, 7
    s_mul_i32 s67, s55, 196608
    s_add_u32 m0, s88, 8192
    s_nop 0
    buffer_load_dwordx4 v10, s[60:63], s67 offen lds
    v_mfma_f32_32x32x16_bf16 v[16:31], v[200:203], v[64:67], v[16:31]
    ds_read_b64_tr_b16 v[98:99], v6 offset:53760
    ds_read_b64_tr_b16 v[100:101], v6 offset:61440
    v_mfma_f32_32x32x16_bf16 v[32:47], v[200:203], v[68:71], v[32:47]
    ds_read_b64_tr_b16 v[102:103], v6 offset:61952
    ds_read_b128 v[220:223], v5 offset:32768
    s_add_u32 s55, s91, 2
    s_and_b32 s55, s55, 7
    s_lshl_b32 s66, s55, 7
    s_mul_i32 s67, s55, 196608
    s_add_u32 m0, s88, 16384
    s_nop 0
    buffer_load_dwordx4 v10, s[60:63], s67 offen lds
    v_mfma_f32_32x32x16_bf16 v[16:31], v[204:207], v[72:75], v[16:31]
    ds_read_b64_tr_b16 v[104:105], v6 offset:55296
    ds_read_b64_tr_b16 v[106:107], v6 offset:55808
    v_mfma_f32_32x32x16_bf16 v[32:47], v[204:207], v[76:79], v[32:47]
    ds_read_b64_tr_b16 v[108:109], v6 offset:63488
    ds_read_b64_tr_b16 v[110:111], v6 offset:64000
    s_add_u32 s55, s91, 3
    s_and_b32 s55, s55, 7
    s_lshl_b32 s66, s55, 7
    s_mul_i32 s67, s55, 196608
    s_add_u32 m0, s88, 24576
    s_nop 0
    buffer_load_dwordx4 v10, s[60:63], s67 offen lds
    s_cmp_eq_u32 s95, 4
    s_cbranch_scc0 L_b_gd4
    v_mov_b32 v11, 0
    v_dot2_f32_bf16 v11, v120, v112, v11
    v_dot2_f32_bf16 v11, v121, v113, v11
    v_dot2_f32_bf16 v11, v122, v114, v11
    v_dot2_f32_bf16 v11, v123, v115, v11
    v_dot2_f32_bf16 v11, v124, v116, v11
    v_dot2_f32_bf16 v11, v125, v117, v11
    v_dot2_f32_bf16 v11, v126, v118, v11
    v_dot2_f32_bf16 v11, v127, v119, v11
L_b_gd4:
    s_cmp_eq_u32 s95, 5
    s_cbranch_scc0 L_b_gr5
    ds_read_b128 v[120:123], v12 offset:32768
    ds_read_b128 v[124:127], v13 offset:32768
L_b_gr5:
    s_waitcnt lgkmcnt(0)
    v_xor_b32 v2, 0x10000, v2
    v_xor_b32 v3, 0x10000, v3
    v_xor_b32 v4, 0x10000, v4
    v_xor_b32 v5, 0x10000, v5
    v_xor_b32 v6, 0x10000, v6
    s_waitcnt vmcnt(8)
    s_barrier
    v_mfma_f32_32x32x16_bf16 v[16:31], v[208:211], v[80:83], v[16:31]
    ds_read_b128 v[224:227], v2 offset:0
    ds_read_b64_tr_b16 v[48:49], v6 offset:16384
    ds_read_b64_tr_b16 v[50:51], v6 offset:16896
    v_mfma_f32_32x32x16_bf16 v[32:47], v[208:211], v[84:87], v[32:47]
    ds_read_b64_tr_b16 v[52:53], v6 offset:24576
    ds_read_b64_tr_b16 v[54:55], v6 offset:25088
    ds_read_b128 v[228:231], v3 offset:0
    s_add_u32 s55, s91, 4
    s_and_b32 s55, s55, 7
    s_lshl_b32 s66, s55, 7
    s_mul_i32 s67, s55, 196608
    s_add_u32 m0, s88, 32768
    s_nop 0
    buffer_load_dwordx4 v10, s[60:63], s67 offen lds
    v_mfma_f32_32x32x16_bf16 v[16:31], v[212:215], v[88:91], v[16:31]
    ds_read_b64_tr_b16 v[56:57], v6 offset:18432
    ds_read_b64_tr_b16 v[58:59], v6 offset:18944
    ds_read_b64_tr_b16 v[60:61], v6 offset:26624
    v_mfma_f32_32x32x16_bf16 v[32:47], v[212:215], v[92:95], v[32:47]
    ds_read_b64_tr_b16 v[62:63], v6 offset:27136
    ds_read_b128 v[232:235], v4 offset:0
    ds_read_b64_tr_b16 v[64:65], v6 offset:20480
    s_add_u32 s55, s91, 5
    s_and_b32 s55, s55, 7
    s_lshl_b32 s66, s55, 7
    s_mul_i32 s67, s55, 196608
    s_add_u32 m0, s88, 40960
    s_nop 0
    buffer_load_dwordx4 v10, s[60:63], s67 offen lds
    v_mfma_f32_32x32x16_bf16 v[16:31], v[216:219], v[96:99], v[16:31]
    ds_read_b64_tr_b16 v[66:67], v6 offset:20992
    ds_read_b64_tr_b16 v[68:69], v6 offset:28672
    v_mfma_f32_32x32x16_bf16 v[32:47], v[216:219], v[100:103], v[32:47]
    ds_read_b64_tr_b16 v[70:71], v6 offset:29184
    ds_read_b128 v[236:239], v5 offset:0
    s_add_u32 s55, s91, 6
    s_and_b32 s55, s55, 7
    s_lshl_b32 s66, s55, 7
    s_mul_i32 s67, s55, 196608
    s_add_u32 m0, s88, 49152
    s_nop 0
    buffer_load_dwordx4 v10, s[60:63], s67 offen lds
    v_mfma_f32_32x32x16_bf16 v[16:31], v[220:223], v[104:107], v[16:31]
    ds_read_b64_tr_b16 v[72:73], v6 offset:22528
    ds_read_b64_tr_b16 v[74:75], v6 offset:23040
    v_mfma_f32_32x32x16_bf16 v[32:47], v[220:223], v[108:111], v[32:47]
    ds_read_b64_tr_b16 v[76:77], v6 offset:30720
    ds_read_b64_tr_b16 v[78:79], v6 offset:31232
    s_add_u32 s55, s91, 7
    s_and_b32 s55, s55, 7
    s_lshl_b32 s66, s55, 7
    s_mul_i32 s67, s55, 196608
    s_add_u32 m0, s88, 57344
    s_nop 0
    buffer_load_dwordx4 v10, s[60:63], s67 offen lds
    s_cmp_eq_u32 s95, 5
    s_cbranch_scc0 L_b_gd5
    v_mov_b32 v11, 0
    v_dot2_f32_bf16 v11, v120, v112, v11
    v_dot2_f32_bf16 v11, v121, v113, v11
    v_dot2_f32_bf16 v11, v122, v114, v11
    v_dot2_f32_bf16 v11, v123, v115, v11
    v_dot2_f32_bf16 v11, v124, v116, v11
    v_dot2_f32_bf16 v11, v125, v117, v11
    v_dot2_f32_bf16 v11, v126, v118, v11
    v_dot2_f32_bf16 v11, v127, v119, v11
L_b_gd5:
    s_cmp_eq_u32 s95, 6
    s_cbranch_scc0 L_b_gr6
    v_add_u32 v12, 65536, v12
    v_add_u32 v13, 65536, v13
    ds_read_b128 v[120:123], v12 offset:0
    ds_read_b128 v[124:127], v13 offset:0
L_b_gr6:
    s_waitcnt lgkmcnt(0)
    s_waitcnt vmcnt(8)
    s_barrier
    v_mfma_f32_32x32x16_bf16 v[16:31], v[224:227], v[48:51], v[16:31]
    ds_read_b128 v[240:243], v2 offset:32768
    ds_read_b64_tr_b16 v[80:81], v6 offset:49152
    ds_read_b64_tr_b16 v[82:83], v6 offset:49664
    v_mfma_f32_32x32x16_bf16 v[32:47], v[224:227], v[52:55], v[32:47]
    ds_read_b64_tr_b16 v[84:85], v6 offset:57344
    ds_read_b64_tr_b16 v[86:87], v6 offset:57856
    ds_read_b128 v[244:247], v3 offset:32768
    v_mfma_f32_32x32x16_bf16 v[16:31], v[228:231], v[56:59], v[16:31]
    ds_read_b64_tr_b16 v[88:89], v6 offset:51200
    ds_read_b64_tr_b16 v[90:91], v6 offset:51712
    ds_read_b64_tr_b16 v[92:93], v6 offset:59392
    v_mfma_f32_32x32x16_bf16 v[32:47], v[228:231], v[60:63], v[32:47]
    ds_read_b64_tr_b16 v[94:95], v6 offset:59904
    ds_read_b128 v[248:251], v4 offset:32768
    ds_read_b64_tr_b16 v[96:97], v6 offset:53248
    v_mfma_f32_32x32x16_bf16 v[16:31], v[232:235], v[64:67], v[16:31]
    ds_read_b64_tr_b16 v[98:99], v6 offset:53760
    ds_read_b64_tr_b16 v[100:101], v6 offset:61440
    v_mfma_f32_32x32x16_bf16 v[32:47], v[232:235], v[68:71], v[32:47]
    ds_read_b64_tr_b16 v[102:103], v6 offset:61952
    ds_read_b128 v[252:255], v5 offset:32768
    v_mfma_f32_32x32x16_bf16 v[16:31], v[236:239], v[72:75], v[16:31]
    ds_read_b64_tr_b16 v[104:105], v6 offset:55296
    ds_read_b64_tr_b16 v[106:107], v6 offset:55808
    v_mfma_f32_32x32x16_bf16 v[32:47], v[236:239], v[76:79], v[32:47]
    ds_read_b64_tr_b16 v[108:109], v6 offset:63488
    ds_read_b64_tr_b16 v[110:111], v6 offset:64000
    s_cmp_eq_u32 s48, 0
    s_cbranch_scc0 L_b_nodbg
    s_mov_b32 s92, 0
L_b_zpoll:
    v_add_u32_dpp v14, v14, v14 row_shr:1 row_mask:0xf bank_mask:0xf bound_ctrl:0
    s_nop 1
    v_add_u32_dpp v14, v14, v14 row_shr:2 row_mask:0xf bank_mask:0xf bound_ctrl:0
    s_nop 1
    v_add_u32_dpp v14, v14, v14 row_shr:4 row_mask:0xf bank_mask:0xf bound_ctrl:0
    s_nop 0
    v_readlane_b32 s67, v14, 7
    s_nop 0
    s_cmp_eq_u32 s67, 8
    s_cbranch_scc1 L_b_zok
    s_add_u32 s92, s92, 1
    s_cmp_gt_u32 s92, 0x40000
    s_cbranch_scc1 L_b_zok
    s_sleep 8
    v_and_b32 v7, 7, v1
    v_lshlrev_b32 v7, 2, v7
    global_load_dword v14, v7, s[44:45] sc1
    s_waitcnt vmcnt(0)
    s_branch L_b_zpoll
L_b_zok:
    v_and_b32 v7, 15, v1
    v_lshlrev_b32 v7, 8, v7
    v_add_u32 v7, 4253696, v7
    global_load_dword v15, v7, s[46:47] sc1
L_b_nodbg:
    s_cmp_eq_u32 s95, 6
    s_cbranch_scc0 L_b_gd6
    v_mov_b32 v11, 0
    v_dot2_f32_bf16 v11, v120, v112, v11
    v_dot2_f32_bf16 v11, v121, v113, v11
    v_dot2_f32_bf16 v11, v122, v114, v11
    v_dot2_f32_bf16 v11, v123, v115, v11
    v_dot2_f32_bf16 v11, v124, v116, v11
    v_dot2_f32_bf16 v11, v125, v117, v11
    v_dot2_f32_bf16 v11, v126, v118, v11
    v_dot2_f32_bf16 v11, v127, v119, v11
L_b_gd6:
    s_cmp_eq_u32 s95, 7
    s_cbranch_scc0 L_b_gr7
    v_add_u32 v12, 65536, v12
    v_add_u32 v13, 65536, v13
    ds_read_b128 v[120:123], v12 offset:32768
    ds_read_b128 v[124:127], v13 offset:32768
L_b_gr7:
    s_waitcnt lgkmcnt(0)
    v_xor_b32 v2, 0x10000, v2
    v_xor_b32 v3, 0x10000, v3
    v_xor_b32 v4, 0x10000, v4
    v_xor_b32 v5, 0x10000, v5
    v_xor_b32 v6, 0x10000, v6
    s_waitcnt vmcnt(4)
    s_barrier
    v_mfma_f32_32x32x16_bf16 v[16:31], v[240:243], v[80:83], v[16:31]
    ds_read_b64_tr_b16 v[48:49], v6 offset:0
    ds_read_b64_tr_b16 v[50:51], v6 offset:512
    v_mfma_f32_32x32x16_bf16 v[32:47], v[240:243], v[84:87], v[32:47]
    ds_read_b64_tr_b16 v[52:53], v6 offset:2048
    ds_read_b64_tr_b16 v[54:55], v6 offset:2560
    v_mfma_f32_32x32x16_bf16 v[16:31], v[244:247], v[88:91], v[16:31]
    ds_read_b64_tr_b16 v[56:57], v6 offset:4096
    ds_read_b64_tr_b16 v[58:59], v6 offset:4608
    v_mfma_f32_32x32x16_bf16 v[32:47], v[244:247], v[92:95], v[32:47]
    ds_read_b64_tr_b16 v[60:61], v6 offset:6144
    ds_read_b64_tr_b16 v[62:63], v6 offset:6656
    v_mfma_f32_32x32x16_bf16 v[16:31], v[248:251], v[96:99], v[16:31]
    ds_read_b64_tr_b16 v[64:65], v6 offset:8192
    v_mfma_f32_32x32x16_bf16 v[32:47], v[248:251], v[100:103], v[32:47]
    ds_read_b64_tr_b16 v[66:67], v6 offset:8704
    v_mfma_f32_32x32x16_bf16 v[16:31], v[252:255], v[104:107], v[16:31]
    ds_read_b64_tr_b16 v[68:69], v6 offset:10240
    v_mfma_f32_32x32x16_bf16 v[32:47], v[252:255], v[108:111], v[32:47]
    ds_read_b64_tr_b16 v[70:71], v6 offset:10752
    s_cmp_eq_u32 s95, 7
    s_cbranch_scc0 L_b_gd7
    v_mov_b32 v11, 0
    v_dot2_f32_bf16 v11, v120, v112, v11
    v_dot2_f32_bf16 v11, v121, v113, v11
    v_dot2_f32_bf16 v11, v122, v114, v11
    v_dot2_f32_bf16 v11, v123, v115, v11
    v_dot2_f32_bf16 v11, v124, v116, v11
    v_dot2_f32_bf16 v11, v125, v117, v11
    v_dot2_f32_bf16 v11, v126, v118, v11
    v_dot2_f32_bf16 v11, v127, v119, v11
L_b_gd7:
    s_waitcnt lgkmcnt(10)
    v_mfma_f32_32x32x16_bf16 v[112:127], v[48:51], v[128:131], 0
    ds_read_b64_tr_b16 v[72:73], v6 offset:12288
    ds_read_b64_tr_b16 v[74:75], v6 offset:12800
    s_waitcnt lgkmcnt(10)
    v_mfma_f32_32x32x16_bf16 v[112:127], v[52:55], v[132:135], v[112:127]
    ds_read_b64_tr_b16 v[76:77], v6 offset:14336
    ds_read_b64_tr_b16 v[78:79], v6 offset:14848
    v_add_f32_dpp v11, v11, v11 quad_perm:[1,0,3,2] row_mask:0xf bank_mask:0xf
    v_mov_b32 v96, 0x3f803f80
    v_mov_b32 v97, 0x3f803f80
    v_mov_b32 v98, 0x3f803f80
    v_mov_b32 v99, 0x3f803f80
    v_pk_mul_f32 v[100:101], v[16:17], s[82:83]
    v_pk_mul_f32 v[102:103], v[18:19], s[82:83]
    v_pk_mul_f32 v[104:105], v[20:21], s[82:83]
    v_pk_mul_f32 v[106:107], v[22:23], s[82:83]
    v_exp_f32_e64 v100, v100 clamp
    v_max_f32 v16, 0, v16
    v_exp_f32_e64 v101, v101 clamp
    v_max_f32 v17, 0, v17
    v_exp_f32_e64 v102, v102 clamp
    v_max_f32 v18, 0, v18
    v_exp_f32_e64 v103, v103 clamp
    v_max_f32 v19, 0, v19
    v_exp_f32_e64 v104, v104 clamp
    v_max_f32 v20, 0, v20
    s_waitcnt lgkmcnt(10)
    v_mfma_f32_32x32x16_bf16 v[112:127], v[56:59], v[136:139], v[112:127]
    v_exp_f32_e64 v105, v105 clamp
    v_max_f32 v21, 0, v21
    v_exp_f32_e64 v106, v106 clamp
    v_max_f32 v22, 0, v22
    v_exp_f32_e64 v107, v107 clamp
    v_max_f32 v23, 0, v23
    v_pk_add_f32 v[16:17], v[16:17], s[84:85]
    v_pk_add_f32 v[18:19], v[18:19], s[84:85]
    v_pk_add_f32 v[20:21], v[20:21], s[84:85]
    v_pk_add_f32 v[22:23], v[22:23], s[84:85]
    v_pk_add_f32 v[16:17], v[16:17], v[100:101]
    v_pk_add_f32 v[18:19], v[18:19], v[102:103]
    v_pk_add_f32 v[20:21], v[20:21], v[104:105]
    v_pk_add_f32 v[22:23], v[22:23], v[106:107]
    v_cvt_pk_bf16_f32 v80, v16, v17
    v_cvt_pk_bf16_f32 v81, v18, v19
    v_cvt_pk_bf16_f32 v82, v20, v21
    v_cvt_pk_bf16_f32 v83, v22, v23
    v_pk_mul_f32 v[100:101], v[24:25], s[82:83]
    s_waitcnt lgkmcnt(8)
    v_mfma_f32_32x32x16_bf16 v[112:127], v[60:63], v[140:143], v[112:127]
    v_pk_mul_f32 v[102:103], v[26:27], s[82:83]
    v_pk_mul_f32 v[104:105], v[28:29], s[82:83]
    v_pk_mul_f32 v[106:107], v[30:31], s[82:83]
    v_exp_f32_e64 v100, v100 clamp
    v_max_f32 v24, 0, v24
    v_exp_f32_e64 v101, v101 clamp
    v_max_f32 v25, 0, v25
    v_exp_f32_e64 v102, v102 clamp
    v_max_f32 v26, 0, v26
    v_exp_f32_e64 v103, v103 clamp
    v_max_f32 v27, 0, v27
    v_exp_f32_e64 v104, v104 clamp
    v_max_f32 v28, 0, v28
    v_exp_f32_e64 v105, v105 clamp
    v_max_f32 v29, 0, v29
    v_exp_f32_e64 v106, v106 clamp
    v_max_f32 v30, 0, v30
    v_exp_f32_e64 v107, v107 clamp
    v_max_f32 v31, 0, v31
    s_waitcnt lgkmcnt(6)
    v_mfma_f32_32x32x16_bf16 v[112:127], v[64:67], v[144:147], v[112:127]
    v_pk_add_f32 v[24:25], v[24:25], s[84:85]
    v_pk_add_f32 v[26:27], v[26:27], s[84:85]
    v_pk_add_f32 v[28:29], v[28:29], s[84:85]
    v_pk_add_f32 v[30:31], v[30:31], s[84:85]
    v_pk_add_f32 v[24:25], v[24:25], v[100:101]
    v_pk_add_f32 v[26:27], v[26:27], v[102:103]
    v_pk_add_f32 v[28:29], v[28:29], v[104:105]
    v_pk_add_f32 v[30:31], v[30:31], v[106:107]
    v_cvt_pk_bf16_f32 v84, v24, v25
    v_cvt_pk_bf16_f32 v85, v26, v27
    v_cvt_pk_bf16_f32 v86, v28, v29
    v_cvt_pk_bf16_f32 v87, v30, v31
    v_add_f32_dpp v11, v11, v11 quad_perm:[2,3,0,1] row_mask:0xf bank_mask:0xf
    v_cvt_pk_bf16_f32 v88, v32, v33
    v_cvt_pk_bf16_f32 v89, v34, v35
    v_cvt_pk_bf16_f32 v90, v36, v37
    v_cvt_pk_bf16_f32 v91, v38, v39
    v_cvt_pk_bf16_f32 v92, v40, v41
    v_cvt_pk_bf16_f32 v93, v42, v43
    s_waitcnt lgkmcnt(4)
    v_mfma_f32_32x32x16_bf16 v[112:127], v[68:71], v[148:151], v[112:127]
    v_cvt_pk_bf16_f32 v94, v44, v45
    v_cvt_pk_bf16_f32 v95, v46, v47
    v_mfma_f32_32x32x16_bf16 v[16:31], v[80:83], v[88:91], 0
    s_nop 0
    v_mfma_f32_32x32x16_bf16 v[16:31], v[84:87], v[92:95], v[16:31]
    v_mfma_f32_32x32x16_bf16 v[32:47], v[80:83], v[96:99], 0
    v_mfma_f32_32x32x16_bf16 v[32:47], v[84:87], v[96:99], v[32:47]
    v_and_b32 v12, 15, v1
    v_bfe_u32 v13, v1, 4, 1
    v_lshrrev_b32 v7, 5, v1
    v_mul_u32_u24 v12, 68, v12
    v_mul_u32_u24 v8, 1156, v13
    v_add_u32 v12, v12, v8
    v_lshl_add_u32 v12, v7, 5, v12
    s_mul_i32 s55, s53, 4624
    s_mul_i32 s64, s54, 2312
    s_add_u32 s55, s55, s64
    s_add_u32 s55, s55, 65536
    v_add_u32 v12, s55, v12
    v_cmp_eq_u32_e64 s[98:99], 1, v13
    s_waitcnt lgkmcnt(2)
    v_mfma_f32_32x32x16_bf16 v[112:127], v[72:75], v[152:155], v[112:127]
    s_lshr_b32 s64, s48, 1
    s_and_b32 s65, s48, 1
    v_lshrrev_b32 v2, 4, v1
    v_and_b32 v3, 15, v1
    s_lshl_b32 s55, s65, 3
    v_add_u32 v2, s55, v2
    v_mul_u32_u24 v8, 68, v2
    v_lshl_add_u32 v8, v3, 2, v8
    s_mul_i32 s55, s64, 1156
    s_add_u32 s55, s55, 65536
    v_add_u32 v8, s55, v8
    s_lshl_b32 s55, s52, 2
    s_add_u32 s55, s55, s64
    s_lshl_b32 s64, s55, 10
    v_lshlrev_b32 v9, 6, v2
    v_lshl_add_u32 v9, v3, 2, v9
    v_add_u32 v9, s64, v9
    v_cndmask_b32_e64 v100, v16, v24, s[98:99]
    v_cndmask_b32_e64 v101, v17, v25, s[98:99]
    s_waitcnt lgkmcnt(0)
    v_mfma_f32_32x32x16_bf16 v[112:127], v[76:79], v[156:159], v[112:127]
    v_cndmask_b32_e64 v102, v18, v26, s[98:99]
    v_cndmask_b32_e64 v103, v19, v27, s[98:99]
    v_cndmask_b32_e64 v104, v20, v28, s[98:99]
    v_cndmask_b32_e64 v105, v21, v29, s[98:99]
    v_cndmask_b32_e64 v106, v22, v30, s[98:99]
    v_cndmask_b32_e64 v107, v23, v31, s[98:99]
    v_cndmask_b32_e64 v80, v32, v40, s[98:99]
    v_cndmask_b32_e64 v81, v33, v41, s[98:99]
    v_cndmask_b32_e64 v82, v34, v42, s[98:99]
    v_cndmask_b32_e64 v83, v35, v43, s[98:99]
    v_cndmask_b32_e64 v84, v36, v44, s[98:99]
    v_cndmask_b32_e64 v85, v37, v45, s[98:99]
    v_cndmask_b32_e64 v86, v38, v46, s[98:99]
    v_cndmask_b32_e64 v87, v39, v47, s[98:99]
    ds_write2_b32 v12, v100, v101 offset0:0 offset1:1
    ds_write2_b32 v12, v102, v103 offset0:2 offset1:3
    ds_write2_b32 v12, v104, v105 offset0:4 offset1:5
    ds_write2_b32 v12, v106, v107 offset0:6 offset1:7
    v_add_u32 v12, 1088, v12
    s_mov_b32 s66, 0x00010001
    s_mov_b32 s67, 0x00010001
    s_mov_b64 exec, s[66:67]
    ds_write2_b32 v12, v80, v81 offset0:0 offset1:1
    ds_write2_b32 v12, v82, v83 offset0:2 offset1:3
    ds_write2_b32 v12, v84, v85 offset0:4 offset1:5
    ds_write2_b32 v12, v86, v87 offset0:6 offset1:7
    s_mov_b32 s66, 0x11111111
    s_mov_b32 s67, 0x11111111
    s_mov_b64 exec, s[66:67]
    v_add_u32 v13, 84032, v0
    ds_write_b32 v13, v11
    s_mov_b64 exec, -1
    s_waitcnt vmcnt(0)
    s_cmp_eq_u32 s48, 0
    s_cbranch_scc0 L_b_wfok
    s_mov_b32 s95, 0
L_b_wfpoll:
    v_add_u32_dpp v15, v15, v15 row_shr:1 row_mask:0xf bank_mask:0xf bound_ctrl:0
    s_nop 1
    v_add_u32_dpp v15, v15, v15 row_shr:2 row_mask:0xf bank_mask:0xf bound_ctrl:0
    s_nop 1
    v_add_u32_dpp v15, v15, v15 row_shr:4 row_mask:0xf bank_mask:0xf bound_ctrl:0
    s_nop 1
    v_add_u32_dpp v15, v15, v15 row_shr:8 row_mask:0xf bank_mask:0xf bound_ctrl:0
    s_nop 0
    v_readlane_b32 s66, v15, 15
    s_nop 0
    s_cmp_eq_u32 s66, 128
    s_cbranch_scc1 L_b_wfok
    s_add_u32 s95, s95, 1
    s_cmp_gt_u32 s95, 0x40000
    s_cbranch_scc1 L_b_wfok
    s_sleep 8
    v_and_b32 v5, 15, v1
    v_lshlrev_b32 v5, 8, v5
    v_add_u32 v5, 4253696, v5
    global_load_dword v15, v5, s[46:47] sc1
    s_waitcnt vmcnt(0)
    s_branch L_b_wfpoll
L_b_wfok:
    s_waitcnt lgkmcnt(0)
    s_barrier
    ds_read_b32 v80, v8 offset:0
    ds_read_b32 v81, v8 offset:4624
    ds_read_b32 v82, v8 offset:9248
    ds_read_b32 v83, v8 offset:13872
    ds_read_b32 v84, v8 offset:272
    ds_read_b32 v85, v8 offset:4896
    ds_read_b32 v86, v8 offset:9520
    ds_read_b32 v87, v8 offset:14144
    s_cmp_eq_u32 s48, 0
    s_cbranch_scc0 L_b_nz0
    v_lshrrev_b32 v2, 4, v1
    v_and_b32 v3, 15, v1
    v_mul_u32_u24 v2, 1156, v2
    v_lshl_add_u32 v2, v3, 2, v2
    v_add_u32 v2, 66624, v2
    ds_read_b32 v88, v2 offset:0
    ds_read_b32 v89, v2 offset:4624
    ds_read_b32 v90, v2 offset:9248
    ds_read_b32 v91, v2 offset:13872
    s_lshl_b32 s66, s52, 8
    s_add_u32 s66, s66, 32768
    v_lshlrev_b32 v10, 2, v1
    v_add_u32 v10, s66, v10
    s_branch L_b_nz1
L_b_nz0:
    s_cmp_le_u32 s48, 2
    s_cbranch_scc0 L_b_nz1
    s_sub_u32 s66, s48, 1
    s_lshl_b32 s66, s66, 8
    v_lshlrev_b32 v2, 2, v1
    v_add_u32 v2, s66, v2
    v_add_u32 v3, 84032, v2
    ds_read_b32 v88, v3
    v_mov_b32 v89, 0
    v_mov_b32 v90, 0
    v_mov_b32 v91, 0
    s_lshl_b32 s66, s51, 9
    s_add_u32 s66, s66, 34816
    v_add_u32 v10, s66, v2
L_b_nz1:
    ds_read_b64_tr_b16 v[48:49], v6 offset:16384
    ds_read_b64_tr_b16 v[50:51], v6 offset:16896
    ds_read_b64_tr_b16 v[52:53], v6 offset:18432
    ds_read_b64_tr_b16 v[54:55], v6 offset:18944
    ds_read_b64_tr_b16 v[56:57], v6 offset:20480
    ds_read_b64_tr_b16 v[58:59], v6 offset:20992
    ds_read_b64_tr_b16 v[60:61], v6 offset:22528
    ds_read_b64_tr_b16 v[62:63], v6 offset:23040
    ds_read_b64_tr_b16 v[64:65], v6 offset:24576
    ds_read_b64_tr_b16 v[66:67], v6 offset:25088
    ds_read_b64_tr_b16 v[68:69], v6 offset:26624
    ds_read_b64_tr_b16 v[70:71], v6 offset:27136
    s_waitcnt lgkmcnt(10)
    v_mfma_f32_32x32x16_bf16 v[112:127], v[48:51], v[160:163], v[112:127]
    ds_read_b64_tr_b16 v[72:73], v6 offset:28672
    ds_read_b64_tr_b16 v[74:75], v6 offset:29184
    v_add_f32 v80, v80, v81
    v_add_f32 v82, v82, v83
    v_add_f32 v84, v84, v85
    v_add_f32 v86, v86, v87
    v_add_f32 v80, v80, v82
    v_add_f32 v84, v84, v86
    global_atomic_add_f32 v9, v80, s[86:87] sc1
    global_atomic_add_f32 v9, v84, s[86:87] offset:256 sc1
    s_cmp_le_u32 s48, 2
    s_cbranch_scc0 L_b_noz
    v_add_f32 v88, v88, v89
    v_add_f32 v90, v90, v91
    v_add_f32 v88, v88, v90
    global_atomic_add_f32 v10, v88, s[86:87] sc1
L_b_noz:
    s_lshl_b32 s55, s51, 2
    s_add_u32 s55, s55, s53
    s_lshl_b32 s55, s55, 5
    s_lshl_b32 s64, s52, 2
    s_add_u32 s55, s55, s64
    s_lshl_b32 s64, s54, 1
    s_add_u32 s55, s55, s64
    s_lshl_b32 s55, s55, 10
    s_add_u32 s55, s55, 2097152
    v_lshlrev_b32 v12, 4, v1
    v_add_u32 v12, s55, v12
    s_waitcnt lgkmcnt(10)
    v_mfma_f32_32x32x16_bf16 v[112:127], v[52:55], v[164:167], v[112:127]
    ds_read_b64_tr_b16 v[76:77], v6 offset:30720
    ds_read_b64_tr_b16 v[78:79], v6 offset:31232
    s_waitcnt lgkmcnt(10)
    v_mfma_f32_32x32x16_bf16 v[112:127], v[56:59], v[168:171], v[112:127]
    ds_read_b64_tr_b16 v[48:49], v6 offset:32768
    ds_read_b64_tr_b16 v[50:51], v6 offset:33280
    s_waitcnt lgkmcnt(10)
    v_mfma_f32_32x32x16_bf16 v[112:127], v[60:63], v[172:175], v[112:127]
    ds_read_b64_tr_b16 v[52:53], v6 offset:34816
    ds_read_b64_tr_b16 v[54:55], v6 offset:35328
    s_waitcnt lgkmcnt(10)
    v_mfma_f32_32x32x16_bf16 v[112:127], v[64:67], v[176:179], v[112:127]
    ds_read_b64_tr_b16 v[56:57], v6 offset:36864
    ds_read_b64_tr_b16 v[58:59], v6 offset:37376
    s_waitcnt lgkmcnt(10)
    v_mfma_f32_32x32x16_bf16 v[112:127], v[68:71], v[180:183], v[112:127]
    ds_read_b64_tr_b16 v[60:61], v6 offset:38912
    ds_read_b64_tr_b16 v[62:63], v6 offset:39424
    s_waitcnt lgkmcnt(10)
    v_mfma_f32_32x32x16_bf16 v[112:127], v[72:75], v[184:187], v[112:127]
    ds_read_b64_tr_b16 v[64:65], v6 offset:40960
    ds_read_b64_tr_b16 v[66:67], v6 offset:41472
    s_waitcnt lgkmcnt(10)
    v_mfma_f32_32x32x16_bf16 v[112:127], v[76:79], v[188:191], v[112:127]
    ds_read_b64_tr_b16 v[68:69], v6 offset:43008
    ds_read_b64_tr_b16 v[70:71], v6 offset:43520
    s_waitcnt lgkmcnt(10)
    v_mfma_f32_32x32x16_bf16 v[112:127], v[48:51], v[192:195], v[112:127]
    ds_read_b64_tr_b16 v[72:73], v6 offset:45056
    ds_read_b64_tr_b16 v[74:75], v6 offset:45568
    s_waitcnt lgkmcnt(10)
    v_mfma_f32_32x32x16_bf16 v[112:127], v[52:55], v[196:199], v[112:127]
    ds_read_b64_tr_b16 v[76:77], v6 offset:47104
    ds_read_b64_tr_b16 v[78:79], v6 offset:47616
    s_waitcnt lgkmcnt(10)
    v_mfma_f32_32x32x16_bf16 v[112:127], v[56:59], v[200:203], v[112:127]
    ds_read_b64_tr_b16 v[48:49], v6 offset:49152
    ds_read_b64_tr_b16 v[50:51], v6 offset:49664
    s_waitcnt lgkmcnt(10)
    v_mfma_f32_32x32x16_bf16 v[112:127], v[60:63], v[204:207], v[112:127]
    ds_read_b64_tr_b16 v[52:53], v6 offset:51200
    ds_read_b64_tr_b16 v[54:55], v6 offset:51712
    s_waitcnt lgkmcnt(10)
    v_mfma_f32_32x32x16_bf16 v[112:127], v[64:67], v[208:211], v[112:127]
    ds_read_b64_tr_b16 v[56:57], v6 offset:53248
    ds_read_b64_tr_b16 v[58:59], v6 offset:53760
    s_waitcnt lgkmcnt(10)
    v_mfma_f32_32x32x16_bf16 v[112:127], v[68:71], v[212:215], v[112:127]
    ds_read_b64_tr_b16 v[60:61], v6 offset:55296
    ds_read_b64_tr_b16 v[62:63], v6 offset:55808
    s_waitcnt lgkmcnt(10)
    v_mfma_f32_32x32x16_bf16 v[112:127], v[72:75], v[216:219], v[112:127]
    ds_read_b64_tr_b16 v[64:65], v6 offset:57344
    ds_read_b64_tr_b16 v[66:67], v6 offset:57856
    s_waitcnt lgkmcnt(10)
    v_mfma_f32_32x32x16_bf16 v[112:127], v[76:79], v[220:223], v[112:127]
    ds_read_b64_tr_b16 v[68:69], v6 offset:59392
    ds_read_b64_tr_b16 v[70:71], v6 offset:59904
    s_waitcnt lgkmcnt(10)
    v_mfma_f32_32x32x16_bf16 v[112:127], v[48:51], v[224:227], v[112:127]
    ds_read_b64_tr_b16 v[72:73], v6 offset:61440
    ds_read_b64_tr_b16 v[74:75], v6 offset:61952
    s_waitcnt lgkmcnt(10)
    v_mfma_f32_32x32x16_bf16 v[112:127], v[52:55], v[228:231], v[112:127]
    ds_read_b64_tr_b16 v[76:77], v6 offset:63488
    ds_read_b64_tr_b16 v[78:79], v6 offset:64000
    s_waitcnt lgkmcnt(10)
    v_mfma_f32_32x32x16_bf16 v[112:127], v[56:59], v[232:235], v[112:127]
    s_waitcnt lgkmcnt(8)
    v_mfma_f32_32x32x16_bf16 v[112:127], v[60:63], v[236:239], v[112:127]
    s_waitcnt lgkmcnt(6)
    v_mfma_f32_32x32x16_bf16 v[112:127], v[64:67], v[240:243], v[112:127]
    s_waitcnt lgkmcnt(4)
    v_mfma_f32_32x32x16_bf16 v[112:127], v[68:71], v[244:247], v[112:127]
    s_waitcnt lgkmcnt(2)
    v_mfma_f32_32x32x16_bf16 v[112:127], v[72:75], v[248:251], v[112:127]
    s_waitcnt lgkmcnt(0)
    v_mfma_f32_32x32x16_bf16 v[112:127], v[76:79], v[252:255], v[112:127]
    s_nop 11
    v_pk_mul_f32 v[32:33], v[112:113], s[82:83]
    v_pk_mul_f32 v[34:35], v[114:115], s[82:83]
    v_pk_mul_f32 v[36:37], v[116:117], s[82:83]
    v_pk_mul_f32 v[38:39], v[118:119], s[82:83]
    v_exp_f32_e64 v32, v32 clamp
    v_max_f32 v112, 0, v112
    v_exp_f32_e64 v33, v33 clamp
    v_max_f32 v113, 0, v113
    v_exp_f32_e64 v34, v34 clamp
    v_max_f32 v114, 0, v114
    v_exp_f32_e64 v35, v35 clamp
    v_max_f32 v115, 0, v115
    v_exp_f32_e64 v36, v36 clamp
    v_max_f32 v116, 0, v116
    v_exp_f32_e64 v37, v37 clamp
    v_max_f32 v117, 0, v117
    v_exp_f32_e64 v38, v38 clamp
    v_max_f32 v118, 0, v118
    v_exp_f32_e64 v39, v39 clamp
    v_max_f32 v119, 0, v119
    v_pk_add_f32 v[112:113], v[112:113], s[84:85]
    v_pk_add_f32 v[114:115], v[114:115], s[84:85]
    v_pk_add_f32 v[116:117], v[116:117], s[84:85]
    v_pk_add_f32 v[118:119], v[118:119], s[84:85]
    v_pk_add_f32 v[112:113], v[112:113], v[32:33]
    v_pk_add_f32 v[114:115], v[114:115], v[34:35]
    v_pk_add_f32 v[116:117], v[116:117], v[36:37]
    v_pk_add_f32 v[118:119], v[118:119], v[38:39]
    v_cvt_pk_bf16_f32 v40, v112, v113
    v_cvt_pk_bf16_f32 v41, v114, v115
    v_cvt_pk_bf16_f32 v42, v116, v117
    v_cvt_pk_bf16_f32 v43, v118, v119
    global_store_dwordx4 v12, v[40:43], s[46:47] sc1
    v_pk_mul_f32 v[32:33], v[120:121], s[82:83]
    v_pk_mul_f32 v[34:35], v[122:123], s[82:83]
    v_pk_mul_f32 v[36:37], v[124:125], s[82:83]
    v_pk_mul_f32 v[38:39], v[126:127], s[82:83]
    v_exp_f32_e64 v32, v32 clamp
    v_max_f32 v120, 0, v120
    v_exp_f32_e64 v33, v33 clamp
    v_max_f32 v121, 0, v121
    v_exp_f32_e64 v34, v34 clamp
    v_max_f32 v122, 0, v122
    v_exp_f32_e64 v35, v35 clamp
    v_max_f32 v123, 0, v123
    v_exp_f32_e64 v36, v36 clamp
    v_max_f32 v124, 0, v124
    v_exp_f32_e64 v37, v37 clamp
    v_max_f32 v125, 0, v125
    v_exp_f32_e64 v38, v38 clamp
    v_max_f32 v126, 0, v126
    v_exp_f32_e64 v39, v39 clamp
    v_max_f32 v127, 0, v127
    v_pk_add_f32 v[120:121], v[120:121], s[84:85]
    v_pk_add_f32 v[122:123], v[122:123], s[84:85]
    v_pk_add_f32 v[124:125], v[124:125], s[84:85]
    v_pk_add_f32 v[126:127], v[126:127], s[84:85]
    v_pk_add_f32 v[120:121], v[120:121], v[32:33]
    v_pk_add_f32 v[122:123], v[122:123], v[34:35]
    v_pk_add_f32 v[124:125], v[124:125], v[36:37]
    v_pk_add_f32 v[126:127], v[126:127], v[38:39]
    v_cvt_pk_bf16_f32 v44, v120, v121
    v_cvt_pk_bf16_f32 v45, v122, v123
    v_cvt_pk_bf16_f32 v46, v124, v125
    v_cvt_pk_bf16_f32 v47, v126, v127
    global_store_dwordx4 v12, v[44:47], s[46:47] offset:1024 sc1
L_k1_fin:
    s_waitcnt vmcnt(0)
    s_barrier
    s_add_u32 s86, s46, 4237312
    s_addc_u32 s87, s47, 0
    s_cmp_lg_u32 s48, 0
    s_cbranch_scc1 L_p2_noarr
    s_lshr_b32 s53, s2, 3
    s_and_b32 s53, s53, 7
    s_lshl_b32 s53, s53, 8
    v_and_b32 v2, 7, v0
    v_lshlrev_b32 v2, 11, v2
    v_add_u32 v2, s53, v2
    v_mov_b32 v3, 1
    s_mov_b64 exec, 0xff
    global_atomic_add v2, v3, s[86:87] sc1
    s_mov_b64 exec, -1
L_p2_noarr:
    s_and_b32 s53, s2, 7
    s_lshr_b32 s54, s2, 3
    s_and_b32 s52, s54, 3
    s_lshr_b32 s54, s54, 2
    s_lshl_b32 s51, s53, 3
    s_add_u32 s51, s51, s54
    s_and_b32 s55, s48, 3
    s_lshr_b32 s56, s48, 2
    v_and_b32 v1, 63, v0
    v_and_b32 v2, 31, v1
    v_lshrrev_b32 v3, 5, v1
    v_lshlrev_b32 v4, 4, v1
    v_and_b32 v7, 7, v1
    v_lshlrev_b32 v7, 8, v7
    s_and_b32 s92, s2, 7
    s_lshl_b32 s92, s92, 11
    v_add_u32 v7, s92, v7
    s_lshr_b32 s66, s2, 3
    s_and_b32 s66, s66, 3
    s_lshl_b32 s66, s66, 3
    s_add_u32 s66, s66, s48
    s_lshl_b32 s66, s66, 10
    s_add_u32 s66, s66, 5242880
    v_lshlrev_b32 v21, 4, v1
    v_add_u32 v21, s66, v21
    global_load_dwordx4 v[128:131], v21, s[46:47] sc1
    v_add_u32 v21, 32768, v21
    global_load_dwordx4 v[132:135], v21, s[46:47] sc1
    v_add_u32 v21, 32768, v21
    global_load_dwordx4 v[136:139], v21, s[46:47] sc1
    v_add_u32 v21, 32768, v21
    global_load_dwordx4 v[140:143], v21, s[46:47] sc1
    v_add_u32 v21, 32768, v21
    global_load_dwordx4 v[144:147], v21, s[46:47] sc1
    v_add_u32 v21, 32768, v21
    global_load_dwordx4 v[148:151], v21, s[46:47] sc1
    v_add_u32 v21, 32768, v21
    global_load_dwordx4 v[152:155], v21, s[46:47] sc1
    v_add_u32 v21, 32768, v21
    global_load_dwordx4 v[156:159], v21, s[46:47] sc1
    v_add_u32 v21, 32768, v21
    global_load_dwordx4 v[160:163], v21, s[46:47] sc1
    v_add_u32 v21, 32768, v21
    global_load_dwordx4 v[164:167], v21, s[46:47] sc1
    v_add_u32 v21, 32768, v21
    global_load_dwordx4 v[168:171], v21, s[46:47] sc1
    v_add_u32 v21, 32768, v21
    global_load_dwordx4 v[172:175], v21, s[46:47] sc1
    v_add_u32 v21, 32768, v21
    global_load_dwordx4 v[176:179], v21, s[46:47] sc1
    v_add_u32 v21, 32768, v21
    global_load_dwordx4 v[180:183], v21, s[46:47] sc1
    v_add_u32 v21, 32768, v21
    global_load_dwordx4 v[184:187], v21, s[46:47] sc1
    v_add_u32 v21, 32768, v21
    global_load_dwordx4 v[188:191], v21, s[46:47] sc1
    s_lshl_b32 s53, s51, 5
    s_lshl_b32 s54, s48, 2
    s_add_u32 s53, s53, s54
    s_lshl_b32 s53, s53, 10
    s_add_u32 s53, s53, 2097152
    v_add_u32 v5, s53, v4
    v_and_b32 v52, 15, v1
    v_lshrrev_b32 v53, 4, v1
    s_lshl_b32 s53, s51, 7
    s_add_u32 s53, s53, 4229120
    v_lshlrev_b32 v8, 2, v52
    v_add_u32 v8, s53, v8
    s_lshl_b32 s53, s52, 7
    s_lshl_b32 s54, s48, 4
    s_add_u32 s53, s53, s54
    v_add_u32 v9, s53, v52
    v_lshlrev_b32 v9, 12, v9
    v_lshl_add_u32 v9, v53, 4, v9
    s_lshl_b32 s53, s51, 6
    v_add_u32 v9, s53, v9
    v_and_b32 v6, 1, v53
    v_lshl_add_u32 v6, v6, 4, v52
    s_lshl_b32 s53, s51, 5
    v_add_u32 v6, s53, v6
    v_lshlrev_b32 v6, 10, v6
    v_lshrrev_b32 v10, 1, v53
    v_lshl_add_u32 v6, v10, 4, v6
    s_lshl_b32 s53, s52, 8
    s_lshl_b32 s54, s48, 5
    s_add_u32 s53, s53, s54
    v_add_u32 v6, s53, v6
    v_and_b32 v14, 1, v53
    v_lshl_add_u32 v14, v14, 5, v52
    v_lshlrev_b32 v14, 4, v14
    v_lshl_add_u32 v12, v10, 10, v14
    v_add_u32 v12, 65536, v12
    s_lshl_b32 s53, s48, 12
    s_add_u32 s54, s53, 65536
    v_add_u32 v11, s54, v4
    v_lshrrev_b32 v14, 2, v1
    v_and_b32 v15, 3, v1
    v_lshrrev_b32 v10, 4, v1
    v_xor_b32 v15, v15, v10
    v_lshlrev_b32 v15, 4, v15
    v_lshl_add_u32 v54, v14, 6, v15
    v_lshrrev_b32 v14, 2, v2
    v_lshlrev_b32 v15, 1, v3
    v_xor_b32 v14, v14, v15
    v_and_b32 v14, 3, v14
    v_lshlrev_b32 v14, 4, v14
    v_lshl_add_u32 v24, v2, 6, v14
    v_add_u32 v24, s53, v24
    s_lshl_b32 s54, s48, 8
    s_add_u32 s54, s54, 32768
    v_lshlrev_b32 v25, 5, v3
    v_add_u32 v25, s54, v25
    v_cmp_gt_u32_e64 s[98:99], 16, v2
    s_nop 1
    v_cndmask_b32_e64 v16, v25, v24, s[98:99]
    v_mov_b32 v26, 64
    v_mov_b32 v27, 1024
    v_cndmask_b32_e64 v26, v26, v27, s[98:99]
    v_add_u32 v17, v16, v26
    v_add_u32 v18, v17, v26
    v_add_u32 v19, v18, v26
    v_xor_b32 v20, 16, v16
    v_xor_b32 v21, 16, v17
    v_xor_b32 v22, 16, v18
    v_xor_b32 v23, 16, v19
    v_and_b32 v192, 7, v52
    v_and_b32 v193, 1, v192
    v_lshlrev_b32 v193, 4, v193
    v_mov_b32 v194, 0x3f80
    v_lshlrev_b32 v194, v193, v194
    v_lshrrev_b32 v192, 1, v192
    v_lshrrev_b32 v193, 3, v52
    v_sub_u32 v193, v53, v193
    v_lshl_add_u32 v192, v193, 1, v192
    v_and_b32 v195, 1, v193
    v_cmp_eq_u32_e64 s[98:99], 0, v195
    s_nop 1
    v_cndmask_b32_e64 v194, 0, v194, s[98:99]
    v_cmp_eq_u32_e64 s[98:99], 0, v192
    s_nop 1
    v_cndmask_b32_e64 v24, 0, v194, s[98:99]
    v_cmp_eq_u32_e64 s[98:99], 1, v192
    s_nop 1
    v_cndmask_b32_e64 v25, 0, v194, s[98:99]
    v_cmp_eq_u32_e64 s[98:99], 2, v192
    s_nop 1
    v_cndmask_b32_e64 v26, 0, v194, s[98:99]
    v_cmp_eq_u32_e64 s[98:99], 3, v192
    s_nop 1
    v_cndmask_b32_e64 v27, 0, v194, s[98:99]
    v_cmp_eq_u32_e64 s[98:99], 4, v192
    s_nop 1
    v_cndmask_b32_e64 v28, 0, v194, s[98:99]
    v_cmp_eq_u32_e64 s[98:99], 5, v192
    s_nop 1
    v_cndmask_b32_e64 v29, 0, v194, s[98:99]
    v_cmp_eq_u32_e64 s[98:99], 6, v192
    s_nop 1
    v_cndmask_b32_e64 v30, 0, v194, s[98:99]
    v_cmp_eq_u32_e64 s[98:99], 7, v192
    s_nop 1
    v_cndmask_b32_e64 v31, 0, v194, s[98:99]
    s_add_u32 s64, s46, 4194304
    s_addc_u32 s65, s47, 0
    s_mov_b32 s66, 34816
    s_mov_b32 s67, 0x20000
    s_cmp_lg_u32 s48, 0
    s_cbranch_scc1 L_p2_wait
    s_mov_b32 s92, 0
    s_mov_b64 exec, 0xff
L_p2_poll:
    global_load_dword v13, v7, s[86:87] sc1
    s_waitcnt vmcnt(0)
    v_add_u32_dpp v13, v13, v13 row_shr:1 row_mask:0xf bank_mask:0xf bound_ctrl:0
    s_nop 1
    v_add_u32_dpp v13, v13, v13 row_shr:2 row_mask:0xf bank_mask:0xf bound_ctrl:0
    s_nop 1
    v_add_u32_dpp v13, v13, v13 row_shr:4 row_mask:0xf bank_mask:0xf bound_ctrl:0
    s_nop 0
    v_readlane_b32 s93, v13, 7
    s_add_u32 s92, s92, 1
    s_cmp_eq_u32 s93, 256
    s_cbranch_scc1 L_p2_got
    s_sub_u32 s93, 256, s93
    s_cmp_gt_u32 s93, 32
    s_cbranch_scc0 L_p2_short
    s_sleep 24
L_p2_short:
    s_sleep 4
    s_cmp_lt_u32 s92, 0x40000
    s_cbranch_scc1 L_p2_poll
L_p2_got:
    s_mov_b64 exec, -1
L_p2_wait:
    s_waitcnt lgkmcnt(0)
    s_barrier
    s_lshl_b32 s57, s48, 12
    s_add_u32 m0, s57, 0
    s_add_u32 s53, s57, 0
    buffer_load_dwordx4 v54, s[64:67], s53 offen sc1 lds
    s_add_u32 m0, s57, 1024
    s_add_u32 s53, s57, 1024
    buffer_load_dwordx4 v54, s[64:67], s53 offen sc1 lds
    s_add_u32 m0, s57, 2048
    s_add_u32 s53, s57, 2048
    buffer_load_dwordx4 v54, s[64:67], s53 offen sc1 lds
    s_add_u32 m0, s57, 3072
    s_add_u32 s53, s57, 3072
    buffer_load_dwordx4 v54, s[64:67], s53 offen sc1 lds
    s_lshl_b32 s54, s48, 8
    s_add_u32 m0, s54, 32768
    s_add_u32 s53, s54, 32768
    s_mov_b64 exec, 0xffff
    buffer_load_dwordx4 v4, s[64:67], s53 offen sc1 lds
    s_mov_b64 exec, -1
    global_load_dwordx4 v[32:35], v5, s[46:47] offset:0 sc1
    global_load_dwordx4 v[36:39], v5, s[46:47] offset:1024 sc1
    global_load_dwordx4 v[40:43], v5, s[46:47] offset:2048 sc1
    global_load_dwordx4 v[44:47], v5, s[46:47] offset:3072 sc1
    s_waitcnt vmcnt(4)
    ds_read_b128 v[64:67], v16
    ds_read_b128 v[68:71], v20
    ds_read_b128 v[72:75], v17
    ds_read_b128 v[76:79], v21
    ds_read_b128 v[80:83], v18
    ds_read_b128 v[84:87], v22
    ds_read_b128 v[88:91], v19
    ds_read_b128 v[92:95], v23
    global_load_dwordx4 v[48:51], v9, s[46:47] sc1
    global_load_dword v13, v8, s[46:47] sc1
    global_load_dword v14, v8, s[46:47] offset:64 sc1
    s_mov_b32 s92, 0x358637bd
    s_waitcnt lgkmcnt(6)
    v_cvt_pk_bf16_f32 v96, v64, v65
    v_cvt_pk_bf16_f32 v97, v66, v67
    v_cvt_pk_bf16_f32 v98, v68, v69
    v_cvt_pk_bf16_f32 v99, v70, v71
    s_waitcnt lgkmcnt(4)
    v_cvt_pk_bf16_f32 v100, v72, v73
    v_cvt_pk_bf16_f32 v101, v74, v75
    v_cvt_pk_bf16_f32 v102, v76, v77
    v_cvt_pk_bf16_f32 v103, v78, v79
    s_waitcnt lgkmcnt(2)
    v_cvt_pk_bf16_f32 v104, v80, v81
    v_cvt_pk_bf16_f32 v105, v82, v83
    v_cvt_pk_bf16_f32 v106, v84, v85
    v_cvt_pk_bf16_f32 v107, v86, v87
    s_waitcnt lgkmcnt(0)
    v_cvt_pk_bf16_f32 v108, v88, v89
    v_cvt_pk_bf16_f32 v109, v90, v91
    v_cvt_pk_bf16_f32 v110, v92, v93
    v_cvt_pk_bf16_f32 v111, v94, v95
    s_waitcnt vmcnt(3)
    v_mfma_f32_32x32x16_bf16 v[192:207], v[96:99], v[32:35], 0
    v_mfma_f32_32x32x16_bf16 v[208:223], v[100:103], v[36:39], 0
    v_mfma_f32_32x32x16_bf16 v[224:239], v[104:107], v[40:43], 0
    v_mfma_f32_32x32x16_bf16 v[240:255], v[108:111], v[44:47], 0
    s_nop 8
    v_add_f32 v200, s92, v200
    v_rcp_f32 v200, v200
    v_add_f32 v216, s92, v216
    v_rcp_f32 v216, v216
    v_add_f32 v232, s92, v232
    v_rcp_f32 v232, v232
    v_add_f32 v248, s92, v248
    v_rcp_f32 v248, v248
    v_pk_mul_f32 v[192:193], v[192:193], v[200:201] op_sel_hi:[1,0]
    v_pk_mul_f32 v[194:195], v[194:195], v[200:201] op_sel_hi:[1,0]
    v_pk_mul_f32 v[196:197], v[196:197], v[200:201] op_sel_hi:[1,0]
    v_pk_mul_f32 v[198:199], v[198:199], v[200:201] op_sel_hi:[1,0]
    v_cvt_pk_bf16_f32 v64, v192, v193
    v_cvt_pk_bf16_f32 v65, v194, v195
    v_cvt_pk_bf16_f32 v66, v196, v197
    v_cvt_pk_bf16_f32 v67, v198, v199
    ds_write_b128 v11, v[64:67] offset:0
    v_pk_mul_f32 v[208:209], v[208:209], v[216:217] op_sel_hi:[1,0]
    v_pk_mul_f32 v[210:211], v[210:211], v[216:217] op_sel_hi:[1,0]
    v_pk_mul_f32 v[212:213], v[212:213], v[216:217] op_sel_hi:[1,0]
    v_pk_mul_f32 v[214:215], v[214:215], v[216:217] op_sel_hi:[1,0]
    v_cvt_pk_bf16_f32 v68, v208, v209
    v_cvt_pk_bf16_f32 v69, v210, v211
    v_cvt_pk_bf16_f32 v70, v212, v213
    v_cvt_pk_bf16_f32 v71, v214, v215
    ds_write_b128 v11, v[68:71] offset:1024
    v_pk_mul_f32 v[224:225], v[224:225], v[232:233] op_sel_hi:[1,0]
    v_pk_mul_f32 v[226:227], v[226:227], v[232:233] op_sel_hi:[1,0]
    v_pk_mul_f32 v[228:229], v[228:229], v[232:233] op_sel_hi:[1,0]
    v_pk_mul_f32 v[230:231], v[230:231], v[232:233] op_sel_hi:[1,0]
    v_cvt_pk_bf16_f32 v72, v224, v225
    v_cvt_pk_bf16_f32 v73, v226, v227
    v_cvt_pk_bf16_f32 v74, v228, v229
    v_cvt_pk_bf16_f32 v75, v230, v231
    ds_write_b128 v11, v[72:75] offset:2048
    v_pk_mul_f32 v[240:241], v[240:241], v[248:249] op_sel_hi:[1,0]
    v_pk_mul_f32 v[242:243], v[242:243], v[248:249] op_sel_hi:[1,0]
    v_pk_mul_f32 v[244:245], v[244:245], v[248:249] op_sel_hi:[1,0]
    v_pk_mul_f32 v[246:247], v[246:247], v[248:249] op_sel_hi:[1,0]
    v_cvt_pk_bf16_f32 v76, v240, v241
    v_cvt_pk_bf16_f32 v77, v242, v243
    v_cvt_pk_bf16_f32 v78, v244, v245
    v_cvt_pk_bf16_f32 v79, v246, v247
    ds_write_b128 v11, v[76:79] offset:3072
    s_waitcnt lgkmcnt(0)
    s_barrier
    ds_read_b128 v[192:195], v12 offset:0
    ds_read_b128 v[196:199], v12 offset:256
    ds_read_b128 v[200:203], v12 offset:2048
    ds_read_b128 v[204:207], v12 offset:2304
    ds_read_b128 v[208:211], v12 offset:4096
    ds_read_b128 v[212:215], v12 offset:4352
    ds_read_b128 v[216:219], v12 offset:6144
    ds_read_b128 v[220:223], v12 offset:6400
    ds_read_b128 v[224:227], v12 offset:8192
    ds_read_b128 v[228:231], v12 offset:8448
    ds_read_b128 v[232:235], v12 offset:10240
    ds_read_b128 v[236:239], v12 offset:10496
    s_waitcnt lgkmcnt(11)
    v_mfma_f32_16x16x32_bf16 v[112:115], v[128:131], v[192:195], 0
    ds_read_b128 v[240:243], v12 offset:12288
    s_waitcnt lgkmcnt(11)
    v_mfma_f32_16x16x32_bf16 v[116:119], v[128:131], v[196:199], 0
    ds_read_b128 v[244:247], v12 offset:12544
    s_waitcnt lgkmcnt(11)
    v_mfma_f32_16x16x32_bf16 v[112:115], v[132:135], v[200:203], v[112:115]
    ds_read_b128 v[248:251], v12 offset:14336
    s_waitcnt lgkmcnt(11)
    v_mfma_f32_16x16x32_bf16 v[116:119], v[132:135], v[204:207], v[116:119]
    ds_read_b128 v[252:255], v12 offset:14592
    s_waitcnt lgkmcnt(11)
    v_mfma_f32_16x16x32_bf16 v[112:115], v[136:139], v[208:211], v[112:115]
    ds_read_b128 v[192:195], v12 offset:16384
    s_waitcnt lgkmcnt(11)
    v_mfma_f32_16x16x32_bf16 v[116:119], v[136:139], v[212:215], v[116:119]
    ds_read_b128 v[196:199], v12 offset:16640
    s_waitcnt lgkmcnt(11)
    v_mfma_f32_16x16x32_bf16 v[112:115], v[140:143], v[216:219], v[112:115]
    ds_read_b128 v[200:203], v12 offset:18432
    s_waitcnt lgkmcnt(11)
    v_mfma_f32_16x16x32_bf16 v[116:119], v[140:143], v[220:223], v[116:119]
    ds_read_b128 v[204:207], v12 offset:18688
    s_waitcnt lgkmcnt(11)
    v_mfma_f32_16x16x32_bf16 v[112:115], v[144:147], v[224:227], v[112:115]
    ds_read_b128 v[208:211], v12 offset:20480
    s_waitcnt lgkmcnt(11)
    v_mfma_f32_16x16x32_bf16 v[116:119], v[144:147], v[228:231], v[116:119]
    ds_read_b128 v[212:215], v12 offset:20736
    s_waitcnt lgkmcnt(11)
    v_mfma_f32_16x16x32_bf16 v[112:115], v[148:151], v[232:235], v[112:115]
    ds_read_b128 v[216:219], v12 offset:22528
    s_waitcnt lgkmcnt(11)
    v_mfma_f32_16x16x32_bf16 v[116:119], v[148:151], v[236:239], v[116:119]
    ds_read_b128 v[220:223], v12 offset:22784
    s_waitcnt lgkmcnt(11)
    v_mfma_f32_16x16x32_bf16 v[112:115], v[152:155], v[240:243], v[112:115]
    ds_read_b128 v[224:227], v12 offset:24576
    s_waitcnt lgkmcnt(11)
    v_mfma_f32_16x16x32_bf16 v[116:119], v[152:155], v[244:247], v[116:119]
    ds_read_b128 v[228:231], v12 offset:24832
    s_waitcnt lgkmcnt(11)
    v_mfma_f32_16x16x32_bf16 v[112:115], v[156:159], v[248:251], v[112:115]
    ds_read_b128 v[232:235], v12 offset:26624
    s_waitcnt lgkmcnt(11)
    v_mfma_f32_16x16x32_bf16 v[116:119], v[156:159], v[252:255], v[116:119]
    ds_read_b128 v[236:239], v12 offset:26880
    s_waitcnt lgkmcnt(11)
    v_mfma_f32_16x16x32_bf16 v[112:115], v[160:163], v[192:195], v[112:115]
    ds_read_b128 v[240:243], v12 offset:28672
    s_waitcnt lgkmcnt(11)
    v_mfma_f32_16x16x32_bf16 v[116:119], v[160:163], v[196:199], v[116:119]
    ds_read_b128 v[244:247], v12 offset:28928
    s_waitcnt lgkmcnt(11)
    v_mfma_f32_16x16x32_bf16 v[112:115], v[164:167], v[200:203], v[112:115]
    ds_read_b128 v[248:251], v12 offset:30720
    s_waitcnt lgkmcnt(11)
    v_mfma_f32_16x16x32_bf16 v[116:119], v[164:167], v[204:207], v[116:119]
    ds_read_b128 v[252:255], v12 offset:30976
    s_waitcnt lgkmcnt(11)
    v_mfma_f32_16x16x32_bf16 v[112:115], v[168:171], v[208:211], v[112:115]
    s_waitcnt vmcnt(0)
    v_mul_f32 v13, 0xbfb8aa3b, v13
    v_mul_f32 v14, 0xbfb8aa3b, v14
    v_exp_f32 v13, v13
    v_exp_f32 v14, v14
    s_waitcnt lgkmcnt(10)
    v_mfma_f32_16x16x32_bf16 v[116:119], v[168:171], v[212:215], v[116:119]
    s_waitcnt lgkmcnt(9)
    v_mfma_f32_16x16x32_bf16 v[112:115], v[172:175], v[216:219], v[112:115]
    v_add_f32 v13, 1.0, v13
    v_add_f32 v14, 1.0, v14
    v_rcp_f32 v13, v13
    v_rcp_f32 v14, v14
    s_waitcnt lgkmcnt(8)
    v_mfma_f32_16x16x32_bf16 v[116:119], v[172:175], v[220:223], v[116:119]
    s_waitcnt lgkmcnt(7)
    v_mfma_f32_16x16x32_bf16 v[112:115], v[176:179], v[224:227], v[112:115]
    v_mfma_f32_16x16x32_bf16 v[120:123], v[48:51], v[24:27], 0
    v_mfma_f32_16x16x32_bf16 v[124:127], v[48:51], v[28:31], 0
    s_waitcnt lgkmcnt(6)
    v_mfma_f32_16x16x32_bf16 v[116:119], v[176:179], v[228:231], v[116:119]
    s_waitcnt lgkmcnt(5)
    v_mfma_f32_16x16x32_bf16 v[112:115], v[180:183], v[232:235], v[112:115]
    s_waitcnt lgkmcnt(4)
    v_mfma_f32_16x16x32_bf16 v[116:119], v[180:183], v[236:239], v[116:119]
    s_waitcnt lgkmcnt(3)
    v_mfma_f32_16x16x32_bf16 v[112:115], v[184:187], v[240:243], v[112:115]
    s_waitcnt lgkmcnt(2)
    v_mfma_f32_16x16x32_bf16 v[116:119], v[184:187], v[244:247], v[116:119]
    s_waitcnt lgkmcnt(1)
    v_mfma_f32_16x16x32_bf16 v[112:115], v[188:191], v[248:251], v[112:115]
    s_waitcnt lgkmcnt(0)
    v_mfma_f32_16x16x32_bf16 v[116:119], v[188:191], v[252:255], v[116:119]
    s_nop 5
    v_sub_f32 v120, v120, v112
    v_sub_f32 v121, v121, v113
    v_sub_f32 v122, v122, v114
    v_sub_f32 v123, v123, v115
    v_fma_f32 v120, v120, v13, v112
    v_fma_f32 v121, v121, v13, v113
    v_fma_f32 v122, v122, v13, v114
    v_fma_f32 v123, v123, v13, v115
    v_sub_f32 v124, v124, v116
    v_sub_f32 v125, v125, v117
    v_sub_f32 v126, v126, v118
    v_sub_f32 v127, v127, v119
    v_fma_f32 v124, v124, v14, v116
    v_fma_f32 v125, v125, v14, v117
    v_fma_f32 v126, v126, v14, v118
    v_fma_f32 v127, v127, v14, v119
    v_cvt_pk_bf16_f32 v56, v120, v121
    v_cvt_pk_bf16_f32 v57, v122, v123
    v_cvt_pk_bf16_f32 v58, v124, v125
    v_cvt_pk_bf16_f32 v59, v126, v127
    s_nop 0
    v_permlane16_swap_b32 v56, v58
    v_permlane16_swap_b32 v57, v59
    global_store_dwordx4 v6, v[56:59], s[42:43]
L_k1_end:
    s_endpgm
.section .rodata,"a"
.p2align 6
.amdhsa_kernel gated_mix__ssm_conv_s4__linear_attn_block__prompt_kernel
  .amdhsa_next_free_vgpr 256
  .amdhsa_next_free_sgpr 102
  .amdhsa_accum_offset 256
  .amdhsa_group_segment_fixed_size 0
  .amdhsa_kernarg_size 128
  .amdhsa_user_sgpr_count 2
  .amdhsa_user_sgpr_kernarg_segment_ptr 1
  .amdhsa_system_sgpr_workgroup_id_x 1
.end_amdhsa_kernel
```
